```python
import torch

def _softmax(x, axis=-1):
    return torch.softmax(x, dim=axis)
def _gelu(x):
    return torch.nn.functional.gelu(x, approximate="tanh")
def _silu(x):
    return torch.nn.functional.silu(x)
def _sigmoid(x):
    return torch.sigmoid(x)
def _layernorm(x, axis=-1, eps=1e-5):
    m = x.mean(dim=axis, keepdim=True)
    v = x.var(dim=axis, keepdim=True, unbiased=False)
    return (x - m) / torch.sqrt(v + eps)
def _scatter_add(tgt, idx, src, axis=0):
    return tgt.clone().index_add_(axis, idx, src)
def _segment_sum(src, seg, n):
    out = torch.zeros((n,) + src.shape[1:], dtype=src.dtype)
    return out.index_add_(0, seg, src)
def _pad(x, pw):
    flat = tuple(v for pair in reversed(pw) for v in pair)
    return torch.nn.functional.pad(x, flat)

kernel_name = 'gated_mix__gqa_block_cached__dense_activation_relu__decode'

def setup_inputs():

    _w = (lambda a: (lambda t: t.to(torch.bfloat16) if t.is_floating_point() else t)(torch.as_tensor(a)))
    def _A_setup():
        B, Sq, D = 4, 1, 448
        Hq, Hkv, Sk, Dh = 16, 8, 4096, 256
        assert Hq % Hkv == 0, (Hq, Hkv)
        return {
            "x": _w((lambda *s: torch.randn(*s, dtype=torch.bfloat16) * 0.05)(B, Sq, D)),
            "k_cache": _w((lambda *s: torch.randn(*s, dtype=torch.bfloat16) * 6.4)(B, Hkv, Sk, Dh)),
            "v_cache": _w((lambda *s: torch.randn(*s, dtype=torch.bfloat16) * 0.4)(B, Hkv, Sk, Dh)),
            "wq": _w((lambda *s: torch.randn(*s, dtype=torch.bfloat16) * 6.4)(D, Hq * Dh) * (D ** -0.5)),
            "wo": _w((lambda *s: torch.randn(*s, dtype=torch.bfloat16) * 0.4)(Hq * Dh, D) * ((Hq * Dh) ** -0.5)),
        }
    _A_in = _A_setup()

    def _B_setup():
        B, S, D, Dff = 4, 1, 448, 1792
        return {
            "x": _w((lambda *s: torch.randn(*s, dtype=torch.bfloat16) * 0.05)(B, S, D)),
            "w1": _w((lambda *s: torch.randn(*s, dtype=torch.bfloat16) * 0.05)(D, Dff)),
            "w2": _w((lambda *s: torch.randn(*s, dtype=torch.bfloat16) * 0.05)(Dff, D)),
        }
    _B_in = _B_setup()

    return {
        "A_x": _A_in["x"],
        "A_k_cache": _A_in["k_cache"],
        "A_v_cache": _A_in["v_cache"],
        "A_wq": _A_in["wq"],
        "A_wo": _A_in["wo"],
        "B_x": _B_in["x"],
        "B_w1": _B_in["w1"],
        "B_w2": _B_in["w2"],
        "gate_w": _w((lambda *s: torch.randn(*s, dtype=torch.bfloat16) * 0.05)(448) * 16.0),
    }

def reference(A_x, A_k_cache, A_v_cache, A_wq, A_wo, B_x, B_w1, B_w2, gate_w):
    def _A_ref(x, k_cache, v_cache, wq, wo):
        B, Sq, D = x.shape
        Hq, Dh = 16, 256
        Hkv = k_cache.shape[1]
        rep = Hq // Hkv
        q = (lambda x, *d: x.permute(*d))((x @ wq).reshape(B, Sq, Hq, Dh), 0, 2, 1, 3)
        k = (lambda x, n, axis: torch.repeat_interleave(x, n, dim=axis))(k_cache, rep, axis=1)
        v = (lambda x, n, axis: torch.repeat_interleave(x, n, dim=axis))(v_cache, rep, axis=1)
        scores = torch.einsum("bhqd,bhkd->bhqk", q, k) * (Dh ** -0.5)
        p = _softmax(scores, axis=-1)
        o = torch.einsum("bhqk,bhkd->bhqd", p, v)
        return (lambda x, *d: x.permute(*d))(o, 0, 2, 1, 3).reshape(B, Sq, Hq * Dh) @ wo

    def _B_ref(x, w1, w2):
        h = torch.einsum("bsd,df->bsf", x, w1)
        zero = torch.zeros_like(h)
        h = torch.maximum(h, zero)
        return torch.einsum("bsf,fd->bsd", h, w2)

    x = A_x
    g = _sigmoid((x * gate_w).sum(-1, keepdims=True))
    a = _A_ref(x, A_k_cache, A_v_cache, A_wq, A_wo)
    b = _B_ref(x, B_w1, B_w2)
    return g * a + (1 - g) * b
```

```asm
; @launch grid=(256,1,1) block=(256,1,1) lds=163840
.amdgcn_target "amdgcn-amd-amdhsa--gfx950"
.text
.globl gated_mix__gqa_block_cached__dense_activation_relu__decode_kernel
.p2align 8
.type gated_mix__gqa_block_cached__dense_activation_relu__decode_kernel,@function
gated_mix__gqa_block_cached__dense_activation_relu__decode_kernel:
    s_cmp_ge_u32 s2, 256
    s_cbranch_scc1 L_end
    s_load_dwordx16 s[4:19], s[0:1], 0
    s_load_dwordx8 s[20:27], s[0:1], 64
    v_lshrrev_b32 v16, 6, v0
    v_and_b32 v1, 63, v0
    v_readfirstlane_b32 s3, v16
    s_cmp_eq_u32 s3, 3
    s_cbranch_scc0 L_nopf
    s_getpc_b64 s[96:97]
L_pc:
    s_sub_u32 s96, s96, L_pc-gated_mix__gqa_block_cached__dense_activation_relu__decode_kernel
    s_subb_u32 s97, s97, 0
    v_lshlrev_b32 v17, 7, v1
    v_min_u32 v18, L_code_end-gated_mix__gqa_block_cached__dense_activation_relu__decode_kernel-4, v17
    global_load_dword v255, v18, s[96:97]
    v_add_u32 v17, 0x2000, v17
    v_min_u32 v18, L_code_end-gated_mix__gqa_block_cached__dense_activation_relu__decode_kernel-4, v17
    global_load_dword v255, v18, s[96:97]
L_nopf:
    s_lshr_b32 s64, s2, 3
    s_and_b32 s65, s2, 7
    s_lshr_b32 s66, s64, 3
    s_and_b32 s67, s64, 7
    s_add_u32 s68, s65, s67
    s_and_b32 s68, s68, 7
    s_lshl_b32 s70, s3, 15
    s_lshl_b32 s71, s64, 21
    s_lshl_b32 s69, s68, 18
    s_add_u32 s71, s71, s69
    s_lshl_b32 s69, s3, 13
    s_add_u32 s71, s71, s69
    v_lshrrev_b32 v16, 5, v1
    v_and_b32 v17, 31, v1
    v_lshlrev_b32 v18, 2, v16
    v_xor_b32 v17, v17, v18
    v_lshlrev_b32 v17, 4, v17
    v_lshl_or_b32 v2, v16, 9, v17
    v_xor_b32 v3, 128, v2
    v_xor_b32 v4, 16, v2
    v_xor_b32 v5, 144, v2
    v_xor_b32 v6, 32, v2
    v_xor_b32 v7, 160, v2
    v_xor_b32 v8, 48, v2
    v_xor_b32 v9, 176, v2
    v_lshrrev_b32 v20, 4, v1
    v_and_b32 v21, 15, v1
    s_waitcnt lgkmcnt(0)
    s_mov_b32 s28, s6
    s_and_b32 s29, s7, 0xffff
    s_mov_b32 s30, 67108864
    s_mov_b32 s31, 0x20000
    s_add_u32 s69, s71, 0
    s_add_u32 m0, s70, 0
    s_nop 0
    buffer_load_dwordx4 v2, s[28:31], s69 offen offset:0 nt lds
    buffer_load_dwordx4 v3, s[28:31], s69 offen offset:1024 nt lds
    buffer_load_dwordx4 v4, s[28:31], s69 offen offset:2048 nt lds
    buffer_load_dwordx4 v5, s[28:31], s69 offen offset:3072 nt lds
    s_add_u32 s69, s69, 4096
    s_add_u32 m0, s70, 4096
    s_nop 0
    buffer_load_dwordx4 v6, s[28:31], s69 offen offset:0 nt lds
    buffer_load_dwordx4 v7, s[28:31], s69 offen offset:1024 nt lds
    buffer_load_dwordx4 v8, s[28:31], s69 offen offset:2048 nt lds
    buffer_load_dwordx4 v9, s[28:31], s69 offen offset:3072 nt lds
    s_add_u32 s69, s71, 32768
    s_add_u32 m0, s70, 8192
    s_nop 0
    buffer_load_dwordx4 v2, s[28:31], s69 offen offset:0 nt lds
    buffer_load_dwordx4 v3, s[28:31], s69 offen offset:1024 nt lds
    buffer_load_dwordx4 v4, s[28:31], s69 offen offset:2048 nt lds
    buffer_load_dwordx4 v5, s[28:31], s69 offen offset:3072 nt lds
    s_add_u32 s69, s69, 4096
    s_add_u32 m0, s70, 12288
    s_nop 0
    buffer_load_dwordx4 v6, s[28:31], s69 offen offset:0 nt lds
    buffer_load_dwordx4 v7, s[28:31], s69 offen offset:1024 nt lds
    buffer_load_dwordx4 v8, s[28:31], s69 offen offset:2048 nt lds
    buffer_load_dwordx4 v9, s[28:31], s69 offen offset:3072 nt lds
    s_mov_b32 s32, s8
    s_and_b32 s33, s9, 0xffff
    s_mov_b32 s34, 67108864
    s_mov_b32 s35, 0x20000
    v_lshlrev_b32 v14, 9, v20
    v_lshl_or_b32 v14, v21, 4, v14
    s_load_dword s72, s[26:27], 1015808
    s_mov_b32 s55, 0
    s_and_b32 s69, s65, 1
    s_cmp_eq_u32 s69, 0
    s_cbranch_scc0 L_gateLoads
    s_lshl_b32 s69, s67, 2
    s_lshr_b32 s100, s65, 1
    s_add_u32 s69, s69, s100
    s_cmp_lt_u32 s69, 23
    s_cbranch_scc0 L_gateLoads
    s_mul_i32 s100, s66, 23
    s_add_u32 s69, s69, s100
    s_cmp_lt_u32 s69, 64
    s_cbranch_scc1 L_roleQ
    s_sub_u32 s69, s69, 64
    s_lshl_b32 s100, s69, 7
    s_add_u32 s36, s16, s100
    s_addc_u32 s37, s17, 0
    s_sub_u32 s38, 1605632, s100
    s_movk_i32 s77, 3584
    s_lshl_b32 s52, s69, 8
    s_add_u32 s52, s52, 65536
    s_movk_i32 s53, 7168
    s_mov_b32 s54, 0
    s_branch L_taskLoads
L_roleQ:
    s_lshl_b32 s100, s69, 7
    s_add_u32 s36, s10, s100
    s_addc_u32 s37, s11, 0
    s_sub_u32 s38, 3670016, s100
    s_movk_i32 s77, 8192
    s_lshr_b32 s100, s69, 3
    s_lshl_b32 s52, s100, 13
    s_and_b32 s100, s69, 7
    s_lshl_b32 s100, s100, 8
    s_add_u32 s52, s52, s100
    s_movk_i32 s53, 2048
    s_mov_b32 s54, 0xff800000
L_taskLoads:
    s_and_b32 s37, s37, 0xffff
    s_mov_b32 s39, 0x20000
    s_mov_b32 s40, s4
    s_and_b32 s41, s5, 0xffff
    s_mov_b32 s42, 3584
    s_mov_b32 s43, 0x20000
    v_mul_u32_u24 v16, 896, v20
    v_lshl_add_u32 v16, v21, 4, v16
    s_lshl_b32 s69, s3, 8
    s_lshl_b32 s100, s3, 10
    s_add_u32 m0, s100, 131072
    v_lshrrev_b32 v18, 3, v1
    v_and_b32 v19, 6, v18
    v_and_b32 v17, 7, v1
    v_xor_b32 v19, v19, v17
    v_mul_lo_u32 v18, v18, s77
    v_lshl_add_u32 v17, v19, 4, v18
    buffer_load_dwordx4 v16, s[40:43], s69 offen nt lds
    s_lshl_b32 s100, s77, 3
    s_lshl_b32 s69, s3, 7
    s_mul_i32 s69, s69, s77
    s_add_u32 m0, s70, 16384
    s_nop 0
    buffer_load_dwordx4 v17, s[36:39], s69 offen nt lds
    s_add_u32 m0, s70, 17408
    s_add_u32 s69, s69, s100
    buffer_load_dwordx4 v17, s[36:39], s69 offen nt lds
    s_add_u32 m0, s70, 18432
    s_add_u32 s69, s69, s100
    buffer_load_dwordx4 v17, s[36:39], s69 offen nt lds
    s_add_u32 m0, s70, 19456
    s_add_u32 s69, s69, s100
    buffer_load_dwordx4 v17, s[36:39], s69 offen nt lds
    s_add_u32 m0, s70, 20480
    s_add_u32 s69, s69, s100
    buffer_load_dwordx4 v17, s[36:39], s69 offen nt lds
    s_add_u32 m0, s70, 21504
    s_add_u32 s69, s69, s100
    buffer_load_dwordx4 v17, s[36:39], s69 offen nt lds
    s_add_u32 m0, s70, 22528
    s_add_u32 s69, s69, s100
    buffer_load_dwordx4 v17, s[36:39], s69 offen nt lds
    s_add_u32 m0, s70, 23552
    s_add_u32 s69, s69, s100
    buffer_load_dwordx4 v17, s[36:39], s69 offen nt lds
    s_add_u32 m0, s70, 24576
    s_add_u32 s69, s69, s100
    buffer_load_dwordx4 v17, s[36:39], s69 offen nt lds
    s_add_u32 m0, s70, 25600
    s_add_u32 s69, s69, s100
    buffer_load_dwordx4 v17, s[36:39], s69 offen nt lds
    s_add_u32 m0, s70, 26624
    s_add_u32 s69, s69, s100
    buffer_load_dwordx4 v17, s[36:39], s69 offen nt lds
    s_add_u32 m0, s70, 27648
    s_add_u32 s69, s69, s100
    buffer_load_dwordx4 v17, s[36:39], s69 offen nt lds
    s_add_u32 m0, s70, 28672
    s_add_u32 s69, s69, s100
    buffer_load_dwordx4 v17, s[36:39], s69 offen nt lds
    s_add_u32 m0, s70, 29696
    s_add_u32 s69, s69, s100
    buffer_load_dwordx4 v17, s[36:39], s69 offen nt lds
    s_add_u32 m0, s70, 30720
    s_add_u32 s69, s69, s100
    buffer_load_dwordx4 v17, s[36:39], s69 offen nt lds
    s_add_u32 m0, s70, 31744
    s_add_u32 s69, s69, s100
    buffer_load_dwordx4 v17, s[36:39], s69 offen nt lds
    s_mov_b32 s55, 1
L_gateLoads:
L_roleDone:
    s_add_u32 s79, s71, 0
    buffer_load_dwordx4 a[160:163], v14, s[32:35], s79 offen offset:0 nt
    buffer_load_dwordx4 a[164:167], v14, s[32:35], s79 offen offset:2048 nt
    s_add_u32 s79, s71, 4096
    buffer_load_dwordx4 a[168:171], v14, s[32:35], s79 offen offset:0 nt
    buffer_load_dwordx4 a[172:175], v14, s[32:35], s79 offen offset:2048 nt
    s_add_u32 s79, s71, 32768
    buffer_load_dwordx4 a[176:179], v14, s[32:35], s79 offen offset:0 nt
    buffer_load_dwordx4 a[180:183], v14, s[32:35], s79 offen offset:2048 nt
    s_add_u32 s79, s71, 36864
    buffer_load_dwordx4 a[184:187], v14, s[32:35], s79 offen offset:0 nt
    buffer_load_dwordx4 a[188:191], v14, s[32:35], s79 offen offset:2048 nt
    v_and_b32 v22, 3, v21
    v_lshrrev_b32 v23, 2, v21
    v_lshl_or_b32 v22, v22, 2, v23
    v_xor_b32 v23, v20, v21
    v_lshlrev_b32 v23, 4, v23
    v_lshl_or_b32 v22, v22, 9, v23
    v_add_u32 v10, s70, v22
    v_xor_b32 v11, 64, v10
    v_xor_b32 v12, 128, v10
    v_xor_b32 v13, 192, v10
    s_mov_b32 s74, 0x05040100
    s_mov_b32 s75, 0x07060302
    s_mov_b32 s76, 0x3db8aa3b
    s_cmp_eq_u32 s68, 7
    s_cselect_b32 s100, 0, 3670016
    s_cselect_b32 s101, 0, 1605632
    s_mov_b32 s44, s12
    s_and_b32 s45, s13, 0xffff
    s_mov_b32 s46, s100
    s_mov_b32 s47, 0x20000
    s_mov_b32 s48, s18
    s_and_b32 s49, s19, 0xffff
    s_mov_b32 s50, s101
    s_mov_b32 s51, 0x20000
    s_mov_b32 s56, s22
    s_and_b32 s57, s23, 0xffff
    s_mov_b32 s58, 3584
    s_mov_b32 s59, 0x20000
    s_waitcnt lgkmcnt(0)
    s_add_u32 s72, s72, 1
    s_cmp_eq_u32 s55, 0
    s_cbranch_scc1 L_taskEnd
    s_waitcnt vmcnt(8)
    v_and_b32 v16, 3, v1
    v_lshlrev_b32 v16, 8, v16
    v_lshl_add_u32 v16, v20, 3, v16
    s_lshl_b32 s100, s3, 10
    s_add_u32 s100, s100, 131072
    v_add_u32 v16, s100, v16
    v_lshrrev_b32 v17, 2, v1
    v_and_b32 v24, 6, v17
    v_bfe_u32 v18, v1, 1, 1
    v_xor_b32 v24, v24, v18
    v_lshlrev_b32 v24, 4, v24
    v_lshl_or_b32 v24, v17, 7, v24
    v_and_b32 v18, 1, v1
    v_lshl_or_b32 v24, v18, 3, v24
    s_add_u32 s100, s70, 16384
    v_add_u32 v24, s100, v24
    v_xor_b32 v25, 32, v24
    v_xor_b32 v26, 64, v24
    v_xor_b32 v27, 96, v24
    ds_read_b64 v[80:81], v16 offset:0
    ds_read_b64 v[82:83], v16 offset:32
    ds_read_b64 v[84:85], v16 offset:64
    ds_read_b64 v[86:87], v16 offset:96
    ds_read_b64 v[88:89], v16 offset:128
    ds_read_b64 v[90:91], v16 offset:160
    ds_read_b64 v[92:93], v16 offset:192
    ds_read_b64 v[94:95], v16 offset:224
    s_waitcnt lgkmcnt(7)
    ds_read_b64_tr_b16 v[96:97], v24 offset:0
    ds_read_b64_tr_b16 v[98:99], v24 offset:2048
    ds_read_b64_tr_b16 v[100:101], v25 offset:0
    ds_read_b64_tr_b16 v[102:103], v25 offset:2048
    ds_read_b64_tr_b16 v[104:105], v26 offset:0
    ds_read_b64_tr_b16 v[106:107], v26 offset:2048
    ds_read_b64_tr_b16 v[108:109], v27 offset:0
    ds_read_b64_tr_b16 v[110:111], v27 offset:2048
    s_waitcnt lgkmcnt(7)
    ds_read_b64_tr_b16 v[112:113], v24 offset:4096
    ds_read_b64_tr_b16 v[114:115], v24 offset:6144
    ds_read_b64_tr_b16 v[116:117], v25 offset:4096
    ds_read_b64_tr_b16 v[118:119], v25 offset:6144
    ds_read_b64_tr_b16 v[120:121], v26 offset:4096
    ds_read_b64_tr_b16 v[122:123], v26 offset:6144
    ds_read_b64_tr_b16 v[124:125], v27 offset:4096
    ds_read_b64_tr_b16 v[126:127], v27 offset:6144
    s_waitcnt lgkmcnt(8)
    v_mfma_f32_16x16x32_bf16 v[160:163], v[80:83], v[96:99], 0
    v_mfma_f32_16x16x32_bf16 v[164:167], v[80:83], v[100:103], 0
    v_mfma_f32_16x16x32_bf16 v[168:171], v[80:83], v[104:107], 0
    v_mfma_f32_16x16x32_bf16 v[172:175], v[80:83], v[108:111], 0
    s_waitcnt lgkmcnt(7)
    ds_read_b64_tr_b16 v[128:129], v24 offset:8192
    ds_read_b64_tr_b16 v[130:131], v24 offset:10240
    ds_read_b64_tr_b16 v[132:133], v25 offset:8192
    ds_read_b64_tr_b16 v[134:135], v25 offset:10240
    ds_read_b64_tr_b16 v[136:137], v26 offset:8192
    ds_read_b64_tr_b16 v[138:139], v26 offset:10240
    ds_read_b64_tr_b16 v[140:141], v27 offset:8192
    ds_read_b64_tr_b16 v[142:143], v27 offset:10240
    s_waitcnt lgkmcnt(8)
    v_mfma_f32_16x16x32_bf16 v[160:163], v[84:87], v[112:115], v[160:163]
    v_mfma_f32_16x16x32_bf16 v[164:167], v[84:87], v[116:119], v[164:167]
    v_mfma_f32_16x16x32_bf16 v[168:171], v[84:87], v[120:123], v[168:171]
    v_mfma_f32_16x16x32_bf16 v[172:175], v[84:87], v[124:127], v[172:175]
    s_waitcnt lgkmcnt(7)
    ds_read_b64_tr_b16 v[144:145], v24 offset:12288
    ds_read_b64_tr_b16 v[146:147], v24 offset:14336
    ds_read_b64_tr_b16 v[148:149], v25 offset:12288
    ds_read_b64_tr_b16 v[150:151], v25 offset:14336
    ds_read_b64_tr_b16 v[152:153], v26 offset:12288
    ds_read_b64_tr_b16 v[154:155], v26 offset:14336
    ds_read_b64_tr_b16 v[156:157], v27 offset:12288
    ds_read_b64_tr_b16 v[158:159], v27 offset:14336
    s_waitcnt lgkmcnt(8)
    v_mfma_f32_16x16x32_bf16 v[160:163], v[88:91], v[128:131], v[160:163]
    v_mfma_f32_16x16x32_bf16 v[164:167], v[88:91], v[132:135], v[164:167]
    v_mfma_f32_16x16x32_bf16 v[168:171], v[88:91], v[136:139], v[168:171]
    v_mfma_f32_16x16x32_bf16 v[172:175], v[88:91], v[140:143], v[172:175]
    s_waitcnt lgkmcnt(0)
    v_mfma_f32_16x16x32_bf16 v[160:163], v[92:95], v[144:147], v[160:163]
    v_mfma_f32_16x16x32_bf16 v[164:167], v[92:95], v[148:151], v[164:167]
    v_mfma_f32_16x16x32_bf16 v[168:171], v[92:95], v[152:155], v[168:171]
    v_mfma_f32_16x16x32_bf16 v[172:175], v[92:95], v[156:159], v[172:175]
    s_lshl_b32 s100, s3, 10
    s_add_u32 s100, s100, 135168
    v_lshlrev_b32 v18, 2, v1
    v_add_u32 v19, s100, v18
    s_mov_b32 exec_lo, 0xffff0000
    s_mov_b32 exec_hi, 0
    v_mov_b32 v160, v164
    v_mov_b32 v161, v165
    v_mov_b32 v162, v166
    v_mov_b32 v163, v167
    s_mov_b32 exec_lo, 0
    s_mov_b32 exec_hi, 0xffff
    v_mov_b32 v160, v168
    v_mov_b32 v161, v169
    v_mov_b32 v162, v170
    v_mov_b32 v163, v171
    s_mov_b32 exec_lo, 0
    s_mov_b32 exec_hi, 0xffff0000
    v_mov_b32 v160, v172
    v_mov_b32 v161, v173
    v_mov_b32 v162, v174
    v_mov_b32 v163, v175
    s_mov_b64 exec, -1
    ds_write_b32 v19, v160 offset:0
    ds_write_b32 v19, v161 offset:256
    ds_write_b32 v19, v162 offset:512
    ds_write_b32 v19, v163 offset:768
    s_lshl_b32 s100, s3, 8
    s_add_u32 s100, s100, 135168
    v_add_u32 v19, s100, v18
    s_mul_i32 s100, s3, s53
    s_add_u32 s100, s100, s52
    v_add_u32 v18, s100, v18
    v_mov_b32 v29, s72
    s_waitcnt lgkmcnt(0)
    s_barrier
    ds_read_b32 v160, v19 offset:0
    ds_read_b32 v161, v19 offset:1024
    ds_read_b32 v162, v19 offset:2048
    ds_read_b32 v163, v19 offset:3072
    s_waitcnt lgkmcnt(0)
    v_add_f32 v160, v160, v161
    v_add_f32 v162, v162, v163
    v_add_f32 v160, v160, v162
    v_max_f32 v160, s54, v160
    s_nop 1
    v_mov_b32_dpp v161, v160 quad_perm:[1,0,3,2] row_mask:0xf bank_mask:0xf
    v_cvt_pk_bf16_f32 v28, v160, v161
    s_mov_b32 exec_lo, 0x55555555
    s_mov_b32 exec_hi, 0x55555555
    global_store_dwordx2 v18, v[28:29], s[26:27] sc1
    s_mov_b64 exec, -1
L_taskEnd:
    s_cmp_eq_u32 s55, 1
    s_cselect_b64 s[62:63], -1, 0
    s_mov_b64 vcc, s[62:63]
    s_add_u32 s69, s71, 65536
    s_add_u32 m0, s70, 16384
    s_waitcnt vmcnt(8)
    s_cbranch_vccnz L_w1
    s_waitcnt vmcnt(5)
L_w1:
    buffer_load_dwordx4 v2, s[28:31], s69 offen offset:0 nt lds
    s_waitcnt vmcnt(8)
    s_cbranch_vccnz L_w2
    s_waitcnt vmcnt(5)
L_w2:
    buffer_load_dwordx4 v3, s[28:31], s69 offen offset:1024 nt lds
    s_waitcnt vmcnt(8)
    s_cbranch_vccnz L_w3
    s_waitcnt vmcnt(5)
L_w3:
    buffer_load_dwordx4 v4, s[28:31], s69 offen offset:2048 nt lds
    s_waitcnt vmcnt(8)
    s_cbranch_vccnz L_w4
    s_waitcnt vmcnt(5)
L_w4:
    buffer_load_dwordx4 v5, s[28:31], s69 offen offset:3072 nt lds
    s_add_u32 s69, s69, 4096
    s_add_u32 m0, s70, 20480
    s_waitcnt vmcnt(8)
    s_cbranch_vccnz L_w5
    s_waitcnt vmcnt(5)
L_w5:
    buffer_load_dwordx4 v6, s[28:31], s69 offen offset:0 nt lds
    s_waitcnt vmcnt(8)
    s_cbranch_vccnz L_w6
    s_waitcnt vmcnt(5)
L_w6:
    buffer_load_dwordx4 v7, s[28:31], s69 offen offset:1024 nt lds
    s_waitcnt vmcnt(8)
    s_cbranch_vccnz L_w7
    s_waitcnt vmcnt(5)
L_w7:
    buffer_load_dwordx4 v8, s[28:31], s69 offen offset:2048 nt lds
    s_waitcnt vmcnt(8)
    s_cbranch_vccnz L_w8
    s_waitcnt vmcnt(5)
L_w8:
    buffer_load_dwordx4 v9, s[28:31], s69 offen offset:3072 nt lds
    s_add_u32 s69, s71, 98304
    s_add_u32 m0, s70, 24576
    s_waitcnt vmcnt(8)
    s_cbranch_vccnz L_w9
    s_waitcnt vmcnt(5)
L_w9:
    buffer_load_dwordx4 v2, s[28:31], s69 offen offset:0 nt lds
    s_waitcnt vmcnt(8)
    s_cbranch_vccnz L_w10
    s_waitcnt vmcnt(5)
L_w10:
    buffer_load_dwordx4 v3, s[28:31], s69 offen offset:1024 nt lds
    s_waitcnt vmcnt(8)
    s_cbranch_vccnz L_w11
    s_waitcnt vmcnt(5)
L_w11:
    buffer_load_dwordx4 v4, s[28:31], s69 offen offset:2048 nt lds
    s_waitcnt vmcnt(8)
    s_cbranch_vccnz L_w12
    s_waitcnt vmcnt(5)
L_w12:
    buffer_load_dwordx4 v5, s[28:31], s69 offen offset:3072 nt lds
    s_add_u32 s69, s69, 4096
    s_add_u32 m0, s70, 28672
    s_waitcnt vmcnt(8)
    s_cbranch_vccnz L_w13
    s_waitcnt vmcnt(5)
L_w13:
    buffer_load_dwordx4 v6, s[28:31], s69 offen offset:0 nt lds
    s_waitcnt vmcnt(8)
    s_cbranch_vccnz L_w14
    s_waitcnt vmcnt(5)
L_w14:
    buffer_load_dwordx4 v7, s[28:31], s69 offen offset:1024 nt lds
    s_waitcnt vmcnt(8)
    s_cbranch_vccnz L_w15
    s_waitcnt vmcnt(5)
L_w15:
    buffer_load_dwordx4 v8, s[28:31], s69 offen offset:2048 nt lds
    s_waitcnt vmcnt(8)
    s_cbranch_vccnz L_w16
    s_waitcnt vmcnt(5)
L_w16:
    buffer_load_dwordx4 v9, s[28:31], s69 offen offset:3072 nt lds
    s_add_u32 s79, s71, 0
    s_waitcnt vmcnt(8)
    s_cbranch_vccnz L_w17
    s_waitcnt vmcnt(5)
L_w17:
    buffer_load_dwordx4 a[192:195], v14, s[32:35], s79 offen offset:256 nt
    s_waitcnt vmcnt(8)
    s_cbranch_vccnz L_w18
    s_waitcnt vmcnt(5)
L_w18:
    buffer_load_dwordx4 a[196:199], v14, s[32:35], s79 offen offset:2304 nt
    s_add_u32 s79, s71, 4096
    s_waitcnt vmcnt(8)
    s_cbranch_vccnz L_w19
    s_waitcnt vmcnt(5)
L_w19:
    buffer_load_dwordx4 a[200:203], v14, s[32:35], s79 offen offset:256 nt
    s_waitcnt vmcnt(8)
    s_cbranch_vccnz L_w20
    s_waitcnt vmcnt(5)
L_w20:
    buffer_load_dwordx4 a[204:207], v14, s[32:35], s79 offen offset:2304 nt
    s_add_u32 s79, s71, 32768
    s_waitcnt vmcnt(8)
    s_cbranch_vccnz L_w21
    s_waitcnt vmcnt(5)
L_w21:
    buffer_load_dwordx4 a[208:211], v14, s[32:35], s79 offen offset:256 nt
    s_waitcnt vmcnt(8)
    s_cbranch_vccnz L_w22
    s_waitcnt vmcnt(5)
L_w22:
    buffer_load_dwordx4 a[212:215], v14, s[32:35], s79 offen offset:2304 nt
    s_add_u32 s79, s71, 36864
    s_waitcnt vmcnt(8)
    s_cbranch_vccnz L_w23
    s_waitcnt vmcnt(5)
L_w23:
    buffer_load_dwordx4 a[216:219], v14, s[32:35], s79 offen offset:256 nt
    s_waitcnt vmcnt(8)
    s_cbranch_vccnz L_w24
    s_waitcnt vmcnt(5)
L_w24:
    buffer_load_dwordx4 a[220:223], v14, s[32:35], s79 offen offset:2304 nt
    s_lshl_b32 s69, s67, 2
    s_add_u32 s69, s69, s66
    s_lshl_b32 s69, s69, 11
    s_lshl_b32 s100, s3, 9
    s_add_u32 s69, s69, s100
    v_lshlrev_b32 v15, 3, v1
    v_add_u32 v15, s69, v15
    s_waitcnt vmcnt(8)
    s_cbranch_vccnz L_w25
    s_waitcnt vmcnt(5)
L_w25:
    global_load_dwordx2 v[32:33], v15, s[26:27] sc1
    s_add_u32 s79, s71, 65536
    s_waitcnt vmcnt(8)
    s_cbranch_vccnz L_w26
    s_waitcnt vmcnt(5)
L_w26:
    buffer_load_dwordx4 a[224:227], v14, s[32:35], s79 offen offset:0 nt
    s_waitcnt vmcnt(8)
    s_cbranch_vccnz L_w27
    s_waitcnt vmcnt(5)
L_w27:
    buffer_load_dwordx4 a[228:231], v14, s[32:35], s79 offen offset:2048 nt
    s_add_u32 s79, s71, 69632
    s_waitcnt vmcnt(8)
    s_cbranch_vccnz L_w28
    s_waitcnt vmcnt(5)
L_w28:
    buffer_load_dwordx4 a[232:235], v14, s[32:35], s79 offen offset:0 nt
    s_waitcnt vmcnt(8)
    s_cbranch_vccnz L_w29
    s_waitcnt vmcnt(5)
L_w29:
    buffer_load_dwordx4 a[236:239], v14, s[32:35], s79 offen offset:2048 nt
    s_add_u32 s79, s71, 98304
    s_waitcnt vmcnt(8)
    s_cbranch_vccnz L_w30
    s_waitcnt vmcnt(5)
L_w30:
    buffer_load_dwordx4 a[240:243], v14, s[32:35], s79 offen offset:0 nt
    s_lshl_b32 s100, s3, 8
    s_add_u32 s100, s100, 155648
    v_lshlrev_b32 v16, 2, v1
    v_add_u32 v16, s100, v16
    v_and_b32 v17, 1, v1
    v_lshlrev_b32 v17, 9, v17
    v_lshl_add_u32 v17, v20, 4, v17
    v_add_u32 v17, 155648, v17
    s_waitcnt vmcnt(5)
    s_mov_b32 s101, 0
L_q_chk:
    v_cmp_ne_u32 vcc, s72, v33
    s_cbranch_vccz L_q_ok
    s_add_u32 s101, s101, 1
    s_cmp_gt_u32 s101, 100000
    s_cbranch_scc1 L_q_ok
    global_load_dwordx2 v[32:33], v15, s[26:27] sc1
    s_waitcnt vmcnt(0)
    s_branch L_q_chk
L_q_ok:
    s_mov_b64 vcc, s[62:63]
    ds_write_b32 v16, v32
    s_waitcnt lgkmcnt(0)
    s_barrier
    ds_read_b128 a[64:67], v17 offset:0
    ds_read_b128 a[68:71], v17 offset:64
    ds_read_b128 a[72:75], v17 offset:128
    ds_read_b128 a[76:79], v17 offset:192
    ds_read_b128 a[80:83], v17 offset:256
    ds_read_b128 a[84:87], v17 offset:320
    ds_read_b128 a[88:91], v17 offset:384
    ds_read_b128 a[92:95], v17 offset:448
    v_lshrrev_b32 v22, 3, v1
    v_and_b32 v23, 6, v22
    v_and_b32 v15, 7, v1
    v_xor_b32 v23, v23, v15
    v_mul_u32_u24 v22, 896, v22
    v_lshl_add_u32 v15, v23, 4, v22
    s_lshl_b32 s78, s67, 9
    s_lshl_b32 s100, s66, 7
    s_add_u32 s78, s78, s100
    s_lshl_b32 s100, s3, 5
    s_add_u32 s78, s78, s100
    s_mul_i32 s78, s78, 896
    s_lshl_b32 s101, s68, 7
    s_add_u32 s78, s78, s101
    s_mul_i32 s53, s67, 224
    s_mul_i32 s100, s66, 56
    s_add_u32 s53, s53, s100
    s_lshl_b32 s100, s3, 4
    s_add_u32 s53, s53, s100
    s_mul_i32 s53, s53, 896
    s_add_u32 s53, s53, s101
    s_waitcnt lgkmcnt(0)
    ds_read_b128 a[96:99], v10 offset:0
    ds_read_b128 a[100:103], v11 offset:0
    ds_read_b128 a[104:107], v12 offset:0
    ds_read_b128 a[108:111], v13 offset:0
    ds_read_b128 a[112:115], v10 offset:256
    ds_read_b128 a[116:119], v11 offset:256
    ds_read_b128 a[120:123], v12 offset:256
    ds_read_b128 a[124:127], v13 offset:256
    s_waitcnt lgkmcnt(0)
    ds_read_b128 a[128:131], v10 offset:8192
    ds_read_b128 a[132:135], v11 offset:8192
    ds_read_b128 a[136:139], v12 offset:8192
    ds_read_b128 a[140:143], v13 offset:8192
    ds_read_b128 a[144:147], v10 offset:8448
    ds_read_b128 a[148:151], v11 offset:8448
    ds_read_b128 a[152:155], v12 offset:8448
    ds_read_b128 a[156:159], v13 offset:8448
    s_add_u32 s69, s71, 131072
    s_add_u32 m0, s70, 0
    s_cbranch_vccnz L_w31
    s_waitcnt vmcnt(5)
L_w31:
    buffer_load_dwordx4 v2, s[28:31], s69 offen offset:0 nt lds
    s_cbranch_vccnz L_w32
    s_waitcnt vmcnt(5)
L_w32:
    buffer_load_dwordx4 v3, s[28:31], s69 offen offset:1024 nt lds
    s_cbranch_vccnz L_w33
    s_waitcnt vmcnt(5)
L_w33:
    buffer_load_dwordx4 v4, s[28:31], s69 offen offset:2048 nt lds
    s_cbranch_vccnz L_w34
    s_waitcnt vmcnt(5)
L_w34:
    buffer_load_dwordx4 v5, s[28:31], s69 offen offset:3072 nt lds
    s_add_u32 s69, s69, 4096
    s_add_u32 m0, s70, 4096
    s_waitcnt vmcnt(8)
    s_cbranch_vccnz L_w35
    s_waitcnt vmcnt(5)
L_w35:
    buffer_load_dwordx4 v6, s[28:31], s69 offen offset:0 nt lds
    s_waitcnt vmcnt(8)
    s_cbranch_vccnz L_w36
    s_waitcnt vmcnt(5)
L_w36:
    buffer_load_dwordx4 v7, s[28:31], s69 offen offset:1024 nt lds
    s_waitcnt vmcnt(8)
    s_cbranch_vccnz L_w37
    s_waitcnt vmcnt(5)
L_w37:
    buffer_load_dwordx4 v8, s[28:31], s69 offen offset:2048 nt lds
    s_waitcnt vmcnt(8)
    s_cbranch_vccnz L_w38
    s_waitcnt vmcnt(5)
L_w38:
    buffer_load_dwordx4 v9, s[28:31], s69 offen offset:3072 nt lds
    v_mfma_f32_16x16x32_bf16 v[32:35], a[96:99], a[64:67], 0
    v_mfma_f32_16x16x32_bf16 v[32:35], a[100:103], a[68:71], v[32:35]
    v_mfma_f32_16x16x32_bf16 v[32:35], a[104:107], a[72:75], v[32:35]
    v_mfma_f32_16x16x32_bf16 v[32:35], a[108:111], a[76:79], v[32:35]
    v_mfma_f32_16x16x32_bf16 v[32:35], a[112:115], a[80:83], v[32:35]
    v_mfma_f32_16x16x32_bf16 v[32:35], a[116:119], a[84:87], v[32:35]
    v_mfma_f32_16x16x32_bf16 v[32:35], a[120:123], a[88:91], v[32:35]
    v_mfma_f32_16x16x32_bf16 v[32:35], a[124:127], a[92:95], v[32:35]
    s_waitcnt lgkmcnt(0)
    ds_read_b128 a[96:99], v10 offset:16384
    ds_read_b128 a[100:103], v11 offset:16384
    ds_read_b128 a[104:107], v12 offset:16384
    ds_read_b128 a[108:111], v13 offset:16384
    ds_read_b128 a[112:115], v10 offset:16640
    ds_read_b128 a[116:119], v11 offset:16640
    ds_read_b128 a[120:123], v12 offset:16640
    ds_read_b128 a[124:127], v13 offset:16640
    s_add_u32 s69, s71, 163840
    s_add_u32 m0, s70, 8192
    s_waitcnt vmcnt(8)
    s_cbranch_vccnz L_w39
    s_waitcnt vmcnt(5)
L_w39:
    buffer_load_dwordx4 v2, s[28:31], s69 offen offset:0 nt lds
    s_waitcnt vmcnt(8)
    s_cbranch_vccnz L_w40
    s_waitcnt vmcnt(5)
L_w40:
    buffer_load_dwordx4 v3, s[28:31], s69 offen offset:1024 nt lds
    s_waitcnt vmcnt(8)
    s_cbranch_vccnz L_w41
    s_waitcnt vmcnt(5)
L_w41:
    buffer_load_dwordx4 v4, s[28:31], s69 offen offset:2048 nt lds
    s_waitcnt vmcnt(8)
    s_cbranch_vccnz L_w42
    s_waitcnt vmcnt(5)
L_w42:
    buffer_load_dwordx4 v5, s[28:31], s69 offen offset:3072 nt lds
    s_add_u32 s69, s69, 4096
    s_add_u32 m0, s70, 12288
    s_waitcnt vmcnt(8)
    s_cbranch_vccnz L_w43
    s_waitcnt vmcnt(5)
L_w43:
    buffer_load_dwordx4 v6, s[28:31], s69 offen offset:0 nt lds
    s_waitcnt vmcnt(8)
    s_cbranch_vccnz L_w44
    s_waitcnt vmcnt(5)
L_w44:
    buffer_load_dwordx4 v7, s[28:31], s69 offen offset:1024 nt lds
    s_waitcnt vmcnt(8)
    s_cbranch_vccnz L_w45
    s_waitcnt vmcnt(5)
L_w45:
    buffer_load_dwordx4 v8, s[28:31], s69 offen offset:2048 nt lds
    s_waitcnt vmcnt(8)
    s_cbranch_vccnz L_w46
    s_waitcnt vmcnt(5)
L_w46:
    buffer_load_dwordx4 v9, s[28:31], s69 offen offset:3072 nt lds
    v_mfma_f32_16x16x32_bf16 v[36:39], a[128:131], a[64:67], 0
    v_mfma_f32_16x16x32_bf16 v[36:39], a[132:135], a[68:71], v[36:39]
    v_mfma_f32_16x16x32_bf16 v[36:39], a[136:139], a[72:75], v[36:39]
    v_mfma_f32_16x16x32_bf16 v[36:39], a[140:143], a[76:79], v[36:39]
    v_mfma_f32_16x16x32_bf16 v[36:39], a[144:147], a[80:83], v[36:39]
    v_mfma_f32_16x16x32_bf16 v[36:39], a[148:151], a[84:87], v[36:39]
    v_mfma_f32_16x16x32_bf16 v[36:39], a[152:155], a[88:91], v[36:39]
    v_mfma_f32_16x16x32_bf16 v[36:39], a[156:159], a[92:95], v[36:39]
    s_waitcnt lgkmcnt(0)
    ds_read_b128 a[128:131], v10 offset:24576
    ds_read_b128 a[132:135], v11 offset:24576
    ds_read_b128 a[136:139], v12 offset:24576
    ds_read_b128 a[140:143], v13 offset:24576
    ds_read_b128 a[144:147], v10 offset:24832
    ds_read_b128 a[148:151], v11 offset:24832
    ds_read_b128 a[152:155], v12 offset:24832
    ds_read_b128 a[156:159], v13 offset:24832
    s_add_u32 s69, s71, 196608
    s_add_u32 m0, s70, 16384
    s_waitcnt vmcnt(8)
    s_cbranch_vccnz L_w47
    s_waitcnt vmcnt(5)
L_w47:
    buffer_load_dwordx4 v2, s[28:31], s69 offen offset:0 nt lds
    s_waitcnt vmcnt(8)
    s_cbranch_vccnz L_w48
    s_waitcnt vmcnt(5)
L_w48:
    buffer_load_dwordx4 v3, s[28:31], s69 offen offset:1024 nt lds
    s_waitcnt vmcnt(8)
    s_cbranch_vccnz L_w49
    s_waitcnt vmcnt(5)
L_w49:
    buffer_load_dwordx4 v4, s[28:31], s69 offen offset:2048 nt lds
    s_waitcnt vmcnt(8)
    s_cbranch_vccnz L_w50
    s_waitcnt vmcnt(5)
L_w50:
    buffer_load_dwordx4 v5, s[28:31], s69 offen offset:3072 nt lds
    s_add_u32 s69, s69, 4096
    s_add_u32 m0, s70, 20480
    s_waitcnt vmcnt(8)
    s_cbranch_vccnz L_w51
    s_waitcnt vmcnt(5)
L_w51:
    buffer_load_dwordx4 v6, s[28:31], s69 offen offset:0 nt lds
    s_waitcnt vmcnt(8)
    s_cbranch_vccnz L_w52
    s_waitcnt vmcnt(5)
L_w52:
    buffer_load_dwordx4 v7, s[28:31], s69 offen offset:1024 nt lds
    s_waitcnt vmcnt(8)
    s_cbranch_vccnz L_w53
    s_waitcnt vmcnt(5)
L_w53:
    buffer_load_dwordx4 v8, s[28:31], s69 offen offset:2048 nt lds
    s_waitcnt vmcnt(8)
    s_cbranch_vccnz L_w54
    s_waitcnt vmcnt(5)
L_w54:
    buffer_load_dwordx4 v9, s[28:31], s69 offen offset:3072 nt lds
    v_mfma_f32_16x16x32_bf16 v[40:43], a[96:99], a[64:67], 0
    v_mfma_f32_16x16x32_bf16 v[40:43], a[100:103], a[68:71], v[40:43]
    v_mfma_f32_16x16x32_bf16 v[40:43], a[104:107], a[72:75], v[40:43]
    v_mfma_f32_16x16x32_bf16 v[40:43], a[108:111], a[76:79], v[40:43]
    v_mfma_f32_16x16x32_bf16 v[40:43], a[112:115], a[80:83], v[40:43]
    v_mfma_f32_16x16x32_bf16 v[40:43], a[116:119], a[84:87], v[40:43]
    v_mfma_f32_16x16x32_bf16 v[40:43], a[120:123], a[88:91], v[40:43]
    v_mfma_f32_16x16x32_bf16 v[40:43], a[124:127], a[92:95], v[40:43]
    s_waitcnt lgkmcnt(0)
    s_add_u32 s69, s71, 229376
    s_add_u32 m0, s70, 24576
    s_waitcnt vmcnt(8)
    s_cbranch_vccnz L_w55
    s_waitcnt vmcnt(5)
L_w55:
    buffer_load_dwordx4 v2, s[28:31], s69 offen offset:0 nt lds
    s_waitcnt vmcnt(8)
    s_cbranch_vccnz L_w56
    s_waitcnt vmcnt(5)
L_w56:
    buffer_load_dwordx4 v3, s[28:31], s69 offen offset:1024 nt lds
    s_waitcnt vmcnt(8)
    s_cbranch_vccnz L_w57
    s_waitcnt vmcnt(5)
L_w57:
    buffer_load_dwordx4 v4, s[28:31], s69 offen offset:2048 nt lds
    s_waitcnt vmcnt(8)
    s_cbranch_vccnz L_w58
    s_waitcnt vmcnt(5)
L_w58:
    buffer_load_dwordx4 v5, s[28:31], s69 offen offset:3072 nt lds
    s_add_u32 s69, s69, 4096
    s_add_u32 m0, s70, 28672
    s_waitcnt vmcnt(8)
    s_cbranch_vccnz L_w59
    s_waitcnt vmcnt(5)
L_w59:
    buffer_load_dwordx4 v6, s[28:31], s69 offen offset:0 nt lds
    s_waitcnt vmcnt(8)
    s_cbranch_vccnz L_w60
    s_waitcnt vmcnt(5)
L_w60:
    buffer_load_dwordx4 v7, s[28:31], s69 offen offset:1024 nt lds
    s_waitcnt vmcnt(8)
    s_cbranch_vccnz L_w61
    s_waitcnt vmcnt(5)
L_w61:
    buffer_load_dwordx4 v8, s[28:31], s69 offen offset:2048 nt lds
    s_waitcnt vmcnt(8)
    s_cbranch_vccnz L_w62
    s_waitcnt vmcnt(5)
L_w62:
    buffer_load_dwordx4 v9, s[28:31], s69 offen offset:3072 nt lds
    v_mfma_f32_16x16x32_bf16 v[44:47], a[128:131], a[64:67], 0
    v_mfma_f32_16x16x32_bf16 v[44:47], a[132:135], a[68:71], v[44:47]
    v_mfma_f32_16x16x32_bf16 v[44:47], a[136:139], a[72:75], v[44:47]
    v_mfma_f32_16x16x32_bf16 v[44:47], a[140:143], a[76:79], v[44:47]
    v_mfma_f32_16x16x32_bf16 v[44:47], a[144:147], a[80:83], v[44:47]
    v_mfma_f32_16x16x32_bf16 v[44:47], a[148:151], a[84:87], v[44:47]
    v_mfma_f32_16x16x32_bf16 v[44:47], a[152:155], a[88:91], v[44:47]
    v_mfma_f32_16x16x32_bf16 v[44:47], a[156:159], a[92:95], v[44:47]
    s_mul_i32 s69, s3, 896
    s_mul_i32 s100, s67, 112
    s_add_u32 s69, s69, s100
    s_mul_i32 s100, s66, 28
    s_add_u32 s69, s69, s100
    s_lshl_b32 s69, s69, 3
    s_add_u32 s69, s69, 65536
    v_min_u32 v22, 27, v1
    v_lshlrev_b32 v22, 3, v22
    v_add_u32 v22, s69, v22
    global_load_dwordx2 v[24:25], v22, s[26:27] sc1
    s_waitcnt vmcnt(8)
    s_cbranch_vccnz L_w63
    s_waitcnt vmcnt(5)
L_w63:
    buffer_load_dwordx4 a[244:247], v14, s[32:35], s79 offen offset:2048 nt
    s_add_u32 s79, s71, 102400
    s_waitcnt vmcnt(8)
    s_cbranch_vccnz L_w64
    s_waitcnt vmcnt(5)
L_w64:
    buffer_load_dwordx4 a[248:251], v14, s[32:35], s79 offen offset:0 nt
    s_waitcnt vmcnt(8)
    s_cbranch_vccnz L_w65
    s_waitcnt vmcnt(5)
L_w65:
    buffer_load_dwordx4 a[252:255], v14, s[32:35], s79 offen offset:2048 nt
    s_add_u32 s79, s71, 65536
    s_waitcnt vmcnt(8)
    s_cbranch_vccnz L_w66
    s_waitcnt vmcnt(5)
L_w66:
    buffer_load_dwordx4 v[80:83], v14, s[32:35], s79 offen offset:256 nt
    s_waitcnt vmcnt(8)
    s_cbranch_vccnz L_w67
    s_waitcnt vmcnt(5)
L_w67:
    buffer_load_dwordx4 v[84:87], v14, s[32:35], s79 offen offset:2304 nt
    s_add_u32 s79, s71, 69632
    s_waitcnt vmcnt(8)
    s_cbranch_vccnz L_w68
    s_waitcnt vmcnt(5)
L_w68:
    buffer_load_dwordx4 v[88:91], v14, s[32:35], s79 offen offset:256 nt
    s_waitcnt vmcnt(8)
    s_cbranch_vccnz L_w69
    s_waitcnt vmcnt(5)
L_w69:
    buffer_load_dwordx4 v[92:95], v14, s[32:35], s79 offen offset:2304 nt
    s_add_u32 s79, s71, 98304
    s_waitcnt vmcnt(8)
    s_cbranch_vccnz L_w70
    s_waitcnt vmcnt(5)
L_w70:
    buffer_load_dwordx4 v[96:99], v14, s[32:35], s79 offen offset:256 nt
    ds_read_b128 a[96:99], v10 offset:0
    ds_read_b128 a[100:103], v11 offset:0
    ds_read_b128 a[104:107], v12 offset:0
    ds_read_b128 a[108:111], v13 offset:0
    ds_read_b128 a[112:115], v10 offset:256
    ds_read_b128 a[116:119], v11 offset:256
    ds_read_b128 a[120:123], v12 offset:256
    ds_read_b128 a[124:127], v13 offset:256
    s_waitcnt lgkmcnt(0)
    ds_read_b128 a[128:131], v10 offset:8192
    ds_read_b128 a[132:135], v11 offset:8192
    ds_read_b128 a[136:139], v12 offset:8192
    ds_read_b128 a[140:143], v13 offset:8192
    ds_read_b128 a[144:147], v10 offset:8448
    ds_read_b128 a[148:151], v11 offset:8448
    ds_read_b128 a[152:155], v12 offset:8448
    ds_read_b128 a[156:159], v13 offset:8448
    v_mfma_f32_16x16x32_bf16 v[48:51], a[96:99], a[64:67], 0
    v_mfma_f32_16x16x32_bf16 v[48:51], a[100:103], a[68:71], v[48:51]
    v_mfma_f32_16x16x32_bf16 v[48:51], a[104:107], a[72:75], v[48:51]
    v_mfma_f32_16x16x32_bf16 v[48:51], a[108:111], a[76:79], v[48:51]
    v_mfma_f32_16x16x32_bf16 v[48:51], a[112:115], a[80:83], v[48:51]
    v_mfma_f32_16x16x32_bf16 v[48:51], a[116:119], a[84:87], v[48:51]
    v_mfma_f32_16x16x32_bf16 v[48:51], a[120:123], a[88:91], v[48:51]
    v_mfma_f32_16x16x32_bf16 v[48:51], a[124:127], a[92:95], v[48:51]
    s_waitcnt vmcnt(8)
    s_cbranch_vccnz L_w71
    s_waitcnt vmcnt(5)
L_w71:
    buffer_load_dwordx4 v[100:103], v14, s[32:35], s79 offen offset:2304 nt
    s_add_u32 s79, s71, 102400
    s_waitcnt vmcnt(8)
    s_cbranch_vccnz L_w72
    s_waitcnt vmcnt(5)
L_w72:
    buffer_load_dwordx4 v[104:107], v14, s[32:35], s79 offen offset:256 nt
    s_waitcnt vmcnt(8)
    s_cbranch_vccnz L_w73
    s_waitcnt vmcnt(5)
L_w73:
    buffer_load_dwordx4 v[108:111], v14, s[32:35], s79 offen offset:2304 nt
    s_waitcnt lgkmcnt(0)
    ds_read_b128 a[96:99], v10 offset:16384
    ds_read_b128 a[100:103], v11 offset:16384
    ds_read_b128 a[104:107], v12 offset:16384
    ds_read_b128 a[108:111], v13 offset:16384
    ds_read_b128 a[112:115], v10 offset:16640
    ds_read_b128 a[116:119], v11 offset:16640
    ds_read_b128 a[120:123], v12 offset:16640
    ds_read_b128 a[124:127], v13 offset:16640
    v_mfma_f32_16x16x32_bf16 v[52:55], a[128:131], a[64:67], 0
    v_mfma_f32_16x16x32_bf16 v[52:55], a[132:135], a[68:71], v[52:55]
    v_mfma_f32_16x16x32_bf16 v[52:55], a[136:139], a[72:75], v[52:55]
    v_mfma_f32_16x16x32_bf16 v[52:55], a[140:143], a[76:79], v[52:55]
    v_mfma_f32_16x16x32_bf16 v[52:55], a[144:147], a[80:83], v[52:55]
    v_mfma_f32_16x16x32_bf16 v[52:55], a[148:151], a[84:87], v[52:55]
    v_mfma_f32_16x16x32_bf16 v[52:55], a[152:155], a[88:91], v[52:55]
    v_mfma_f32_16x16x32_bf16 v[52:55], a[156:159], a[92:95], v[52:55]
    s_add_u32 s79, s71, 131072
    s_waitcnt vmcnt(8)
    s_cbranch_vccnz L_w74
    s_waitcnt vmcnt(5)
L_w74:
    buffer_load_dwordx4 v[112:115], v14, s[32:35], s79 offen offset:0 nt
    s_waitcnt vmcnt(8)
    s_cbranch_vccnz L_w75
    s_waitcnt vmcnt(5)
L_w75:
    buffer_load_dwordx4 v[116:119], v14, s[32:35], s79 offen offset:2048 nt
    s_add_u32 s79, s71, 135168
    s_waitcnt vmcnt(8)
    s_cbranch_vccnz L_w76
    s_waitcnt vmcnt(5)
L_w76:
    buffer_load_dwordx4 v[120:123], v14, s[32:35], s79 offen offset:0 nt
    s_waitcnt lgkmcnt(0)
    ds_read_b128 a[128:131], v10 offset:24576
    ds_read_b128 a[132:135], v11 offset:24576
    ds_read_b128 a[136:139], v12 offset:24576
    ds_read_b128 a[140:143], v13 offset:24576
    ds_read_b128 a[144:147], v10 offset:24832
    ds_read_b128 a[148:151], v11 offset:24832
    ds_read_b128 a[152:155], v12 offset:24832
    ds_read_b128 a[156:159], v13 offset:24832
    v_mfma_f32_16x16x32_bf16 v[56:59], a[96:99], a[64:67], 0
    v_mfma_f32_16x16x32_bf16 v[56:59], a[100:103], a[68:71], v[56:59]
    v_mfma_f32_16x16x32_bf16 v[56:59], a[104:107], a[72:75], v[56:59]
    v_mfma_f32_16x16x32_bf16 v[56:59], a[108:111], a[76:79], v[56:59]
    v_mfma_f32_16x16x32_bf16 v[56:59], a[112:115], a[80:83], v[56:59]
    v_mfma_f32_16x16x32_bf16 v[56:59], a[116:119], a[84:87], v[56:59]
    v_mfma_f32_16x16x32_bf16 v[56:59], a[120:123], a[88:91], v[56:59]
    v_mfma_f32_16x16x32_bf16 v[56:59], a[124:127], a[92:95], v[56:59]
    s_waitcnt vmcnt(8)
    s_cbranch_vccnz L_w77
    s_waitcnt vmcnt(5)
L_w77:
    buffer_load_dwordx4 v[124:127], v14, s[32:35], s79 offen offset:2048 nt
    s_add_u32 s79, s71, 163840
    s_waitcnt vmcnt(8)
    s_cbranch_vccnz L_w78
    s_waitcnt vmcnt(5)
L_w78:
    buffer_load_dwordx4 v[128:131], v14, s[32:35], s79 offen offset:0 nt
    s_waitcnt lgkmcnt(0)
    v_mfma_f32_16x16x32_bf16 v[60:63], a[128:131], a[64:67], 0
    v_mfma_f32_16x16x32_bf16 v[60:63], a[132:135], a[68:71], v[60:63]
    v_mfma_f32_16x16x32_bf16 v[60:63], a[136:139], a[72:75], v[60:63]
    v_mfma_f32_16x16x32_bf16 v[60:63], a[140:143], a[76:79], v[60:63]
    v_mfma_f32_16x16x32_bf16 v[60:63], a[144:147], a[80:83], v[60:63]
    v_mfma_f32_16x16x32_bf16 v[60:63], a[148:151], a[84:87], v[60:63]
    v_mfma_f32_16x16x32_bf16 v[60:63], a[152:155], a[88:91], v[60:63]
    v_mfma_f32_16x16x32_bf16 v[60:63], a[156:159], a[92:95], v[60:63]
    s_mov_b64 exec, 0xfffffff
    s_mov_b32 s101, 0
L_h_chk:
    v_cmp_ne_u32 vcc, s72, v25
    s_cbranch_vccz L_h_ok
    s_add_u32 s101, s101, 1
    s_cmp_gt_u32 s101, 100000
    s_cbranch_scc1 L_h_ok
    global_load_dwordx2 v[24:25], v22, s[26:27] sc1
    s_waitcnt vmcnt(0)
    s_branch L_h_chk
L_h_ok:
    s_mov_b64 exec, -1
    v_cmp_gt_u32 vcc, 28, v1
    v_lshlrev_b32 v22, 1, v1
    s_nop 0
    v_cndmask_b32 v24, 0, v24, vcc
    v_lshrrev_b32 v23, 5, v22
    v_lshlrev_b32 v23, 6, v23
    v_bfe_u32 v18, v22, 2, 2
    v_lshl_add_u32 v23, v18, 4, v23
    v_bfe_u32 v18, v22, 4, 1
    v_lshl_add_u32 v23, v18, 3, v23
    v_and_b32 v18, 3, v22
    v_lshl_add_u32 v23, v18, 1, v23
    s_lshl_b32 s100, s3, 7
    s_add_u32 s100, s100, 157696
    v_add_u32 v23, s100, v23
    s_mov_b32 exec_hi, 0
    ds_write_b32 v23, v24
    s_mov_b64 exec, -1
    s_mov_b64 vcc, s[62:63]
    v_max3_f32 v16, v32, v33, v34
    v_max3_f32 v16, v16, v35, v36
    v_max3_f32 v16, v16, v37, v38
    v_max3_f32 v16, v16, v39, v40
    v_max3_f32 v16, v16, v41, v42
    v_max3_f32 v16, v16, v43, v44
    v_max3_f32 v16, v16, v45, v46
    v_max3_f32 v16, v16, v47, v48
    v_max3_f32 v16, v16, v49, v50
    v_max3_f32 v16, v16, v51, v52
    v_max3_f32 v16, v16, v53, v54
    v_max3_f32 v16, v16, v55, v56
    v_max3_f32 v16, v16, v57, v58
    v_max3_f32 v16, v16, v59, v60
    v_max3_f32 v16, v16, v61, v62
    v_max_f32 v16, v16, v63
    v_mov_b32 v22, v16
    s_nop 1
    v_permlane16_swap_b32 v16, v22
    v_max_f32 v16, v16, v22
    v_mov_b32 v22, v16
    s_nop 1
    v_permlane32_swap_b32 v16, v22
    v_max_f32 v16, v16, v22
    v_mul_f32 v16, s76, v16
    v_fma_f32 v32, v32, s76, -v16
    v_fma_f32 v33, v33, s76, -v16
    v_fma_f32 v34, v34, s76, -v16
    v_fma_f32 v35, v35, s76, -v16
    v_fma_f32 v36, v36, s76, -v16
    v_fma_f32 v37, v37, s76, -v16
    v_fma_f32 v38, v38, s76, -v16
    v_fma_f32 v39, v39, s76, -v16
    v_fma_f32 v40, v40, s76, -v16
    v_fma_f32 v41, v41, s76, -v16
    v_fma_f32 v42, v42, s76, -v16
    v_fma_f32 v43, v43, s76, -v16
    v_fma_f32 v44, v44, s76, -v16
    v_fma_f32 v45, v45, s76, -v16
    v_fma_f32 v46, v46, s76, -v16
    v_fma_f32 v47, v47, s76, -v16
    v_fma_f32 v48, v48, s76, -v16
    v_fma_f32 v49, v49, s76, -v16
    v_fma_f32 v50, v50, s76, -v16
    v_fma_f32 v51, v51, s76, -v16
    v_fma_f32 v52, v52, s76, -v16
    v_fma_f32 v53, v53, s76, -v16
    v_fma_f32 v54, v54, s76, -v16
    v_fma_f32 v55, v55, s76, -v16
    v_fma_f32 v56, v56, s76, -v16
    v_fma_f32 v57, v57, s76, -v16
    v_fma_f32 v58, v58, s76, -v16
    v_fma_f32 v59, v59, s76, -v16
    v_fma_f32 v60, v60, s76, -v16
    v_fma_f32 v61, v61, s76, -v16
    v_fma_f32 v62, v62, s76, -v16
    v_fma_f32 v63, v63, s76, -v16
    v_exp_f32 v32, v32
    v_exp_f32 v33, v33
    v_exp_f32 v34, v34
    v_exp_f32 v35, v35
    v_exp_f32 v36, v36
    v_exp_f32 v37, v37
    v_exp_f32 v38, v38
    v_exp_f32 v39, v39
    v_exp_f32 v40, v40
    v_exp_f32 v41, v41
    v_exp_f32 v42, v42
    v_exp_f32 v43, v43
    v_exp_f32 v44, v44
    v_exp_f32 v45, v45
    v_exp_f32 v46, v46
    v_exp_f32 v47, v47
    v_exp_f32 v48, v48
    v_exp_f32 v49, v49
    v_exp_f32 v50, v50
    v_exp_f32 v51, v51
    v_exp_f32 v52, v52
    v_exp_f32 v53, v53
    v_exp_f32 v54, v54
    v_exp_f32 v55, v55
    v_exp_f32 v56, v56
    v_exp_f32 v57, v57
    v_exp_f32 v58, v58
    v_exp_f32 v59, v59
    v_exp_f32 v60, v60
    v_exp_f32 v61, v61
    v_exp_f32 v62, v62
    v_exp_f32 v63, v63
    v_add_f32 v17, v32, v33
    v_add_f32 v17, v17, v34
    v_add_f32 v17, v17, v35
    v_add_f32 v17, v17, v36
    v_add_f32 v17, v17, v37
    v_add_f32 v17, v17, v38
    v_add_f32 v17, v17, v39
    v_add_f32 v17, v17, v40
    v_add_f32 v17, v17, v41
    v_add_f32 v17, v17, v42
    v_add_f32 v17, v17, v43
    v_add_f32 v17, v17, v44
    v_add_f32 v17, v17, v45
    v_add_f32 v17, v17, v46
    v_add_f32 v17, v17, v47
    v_add_f32 v17, v17, v48
    v_add_f32 v17, v17, v49
    v_add_f32 v17, v17, v50
    v_add_f32 v17, v17, v51
    v_add_f32 v17, v17, v52
    v_add_f32 v17, v17, v53
    v_add_f32 v17, v17, v54
    v_add_f32 v17, v17, v55
    v_add_f32 v17, v17, v56
    v_add_f32 v17, v17, v57
    v_add_f32 v17, v17, v58
    v_add_f32 v17, v17, v59
    v_add_f32 v17, v17, v60
    v_add_f32 v17, v17, v61
    v_add_f32 v17, v17, v62
    v_add_f32 v17, v17, v63
    v_cvt_pk_bf16_f32 v240, v32, v33
    v_cvt_pk_bf16_f32 v241, v34, v35
    v_cvt_pk_bf16_f32 v242, v36, v37
    v_cvt_pk_bf16_f32 v243, v38, v39
    v_cvt_pk_bf16_f32 v244, v40, v41
    v_cvt_pk_bf16_f32 v245, v42, v43
    v_cvt_pk_bf16_f32 v246, v44, v45
    v_cvt_pk_bf16_f32 v247, v46, v47
    v_cvt_pk_bf16_f32 v248, v48, v49
    v_cvt_pk_bf16_f32 v249, v50, v51
    v_cvt_pk_bf16_f32 v250, v52, v53
    v_cvt_pk_bf16_f32 v251, v54, v55
    v_cvt_pk_bf16_f32 v252, v56, v57
    v_cvt_pk_bf16_f32 v253, v58, v59
    v_cvt_pk_bf16_f32 v254, v60, v61
    v_cvt_pk_bf16_f32 v255, v62, v63
    v_mov_b32 v22, v17
    s_nop 1
    v_permlane16_swap_b32 v17, v22
    v_add_f32 v17, v17, v22
    v_mov_b32 v22, v17
    s_nop 1
    v_permlane32_swap_b32 v17, v22
    v_add_f32 v17, v17, v22
    v_and_b32 v18, 1, v1
    v_lshlrev_b32 v18, 4, v18
    v_add_u32 v18, 158208, v18
    s_lshl_b32 s100, s3, 2
    v_add_u32 v19, s100, v18
    ds_write_b32 v19, v16 offset:16
    ds_write_b32 v19, v17 offset:64
    s_waitcnt vmcnt(8)
    s_cbranch_vccnz L_w79
    s_waitcnt vmcnt(5)
L_w79:
    buffer_load_dwordx4 v[132:135], v14, s[32:35], s79 offen offset:2048 nt
    s_add_u32 s79, s71, 167936
    s_waitcnt vmcnt(8)
    s_cbranch_vccnz L_w80
    s_waitcnt vmcnt(5)
L_w80:
    buffer_load_dwordx4 v[136:139], v14, s[32:35], s79 offen offset:0 nt
    v_lshlrev_b32 v32, 3, v21
    v_add_u32 v32, s70, v32
    v_and_b32 v22, 3, v1
    v_lshlrev_b32 v22, 8, v22
    v_lshrrev_b32 v23, 2, v1
    v_lshl_add_u32 v22, v23, 3, v22
    s_and_b32 s100, s3, 1
    s_lshl_b32 s100, s100, 10
    s_lshr_b32 s101, s3, 1
    s_lshl_b32 s101, s101, 2
    s_add_u32 s100, s100, s101
    v_add_u32 v33, s100, v22
    v_add_u32 v34, 65536, v33
    s_lshl_b32 s100, s3, 9
    v_lshlrev_b32 v22, 3, v1
    v_add_u32 v22, s100, v22
    s_lshl_b32 s69, s2, 11
    s_add_u32 s69, s69, 393216
    v_add_u32 v35, s69, v22
    s_lshl_b32 s69, s3, 3
    s_add_u32 s69, s69, s67
    s_lshl_b32 s100, s69, 14
    s_lshl_b32 s101, s66, 9
    s_add_u32 s100, s100, s101
    s_add_u32 s100, s100, 397312
    v_lshlrev_b32 v22, 3, v1
    v_add_u32 v36, s100, v22
    v_add_u32 v37, 0x2000, v36
    s_lshl_b32 s69, s69, 8
    s_add_u32 s69, s69, 917504
    v_and_b32 v22, 31, v1
    v_lshlrev_b32 v22, 3, v22
    v_add_u32 v38, s69, v22
    v_lshlrev_b32 v23, 1, v1
    v_lshrrev_b32 v39, 5, v23
    v_lshlrev_b32 v39, 6, v39
    v_bfe_u32 v22, v23, 2, 2
    v_lshl_add_u32 v39, v22, 4, v39
    v_bfe_u32 v22, v23, 4, 1
    v_lshl_add_u32 v39, v22, 3, v39
    v_and_b32 v22, 3, v23
    v_lshl_add_u32 v39, v22, 1, v39
    s_lshl_b32 s100, s3, 8
    s_add_u32 s100, s100, 156672
    v_add_u32 v39, s100, v39
    s_lshl_b32 s69, s68, 14
    s_lshl_b32 s100, s3, 7
    s_add_u32 s69, s69, s100
    s_add_u32 s69, s69, 1048576
    v_lshlrev_b32 v22, 3, v21
    v_add_u32 v22, s69, v22
    s_lshl_b32 s100, s67, 2
    s_add_u32 s100, s100, s66
    s_lshl_b32 s100, s100, 9
    v_lshl_add_u32 v40, v20, 17, v22
    v_add_u32 v40, s100, v40
    s_lshl_b32 s100, s66, 17
    s_add_u32 s100, s100, 0x1000
    v_lshl_add_u32 v41, v20, 9, v22
    v_add_u32 v41, s100, v41
    v_add_u32 v42, 0x2000, v41
    v_lshlrev_b32 v43, 1, v21
    v_mov_b32 v45, s72
    v_mov_b32 v47, s72
    s_mul_i32 s52, s66, 896
    s_lshl_b32 s100, s68, 7
    s_add_u32 s52, s52, s100
    s_lshl_b32 s100, s3, 5
    s_add_u32 s52, s52, s100
    v_lshrrev_b32 v22, 2, v1
    v_and_b32 v25, 6, v22
    v_bfe_u32 v23, v1, 1, 1
    v_xor_b32 v25, v25, v23
    v_lshlrev_b32 v25, 4, v25
    v_lshl_or_b32 v25, v22, 7, v25
    v_and_b32 v23, 1, v1
    v_lshl_or_b32 v25, v23, 3, v25
    s_lshl_b32 s100, s3, 5
    v_xor_b32 v25, s100, v25
    v_add_u32 v26, 147456, v25
    v_add_u32 v25, 131072, v25
    v_and_b32 v23, 3, v1
    v_lshlrev_b32 v27, 8, v23
    v_lshl_add_u32 v27, v20, 4, v27
    v_add_u32 v27, 156672, v27
    v_lshlrev_b32 v22, 7, v23
    v_lshl_add_u32 v22, v20, 4, v22
    v_add_u32 v22, 157696, v22
    v_accvgpr_read_b32 v48, a160
    v_accvgpr_read_b32 v49, a164
    v_accvgpr_read_b32 v50, a168
    v_accvgpr_read_b32 v51, a172
    v_accvgpr_read_b32 v52, a176
    v_accvgpr_read_b32 v53, a180
    v_accvgpr_read_b32 v54, a184
    v_accvgpr_read_b32 v55, a188
    v_perm_b32 v64, v49, v48, s74
    v_perm_b32 v65, v51, v50, s74
    v_perm_b32 v66, v53, v52, s74
    v_perm_b32 v67, v55, v54, s74
    v_perm_b32 v68, v49, v48, s75
    v_perm_b32 v69, v51, v50, s75
    v_perm_b32 v70, v53, v52, s75
    v_perm_b32 v71, v55, v54, s75
    v_mfma_f32_16x16x32_bf16 a[0:3], v[240:243], v[64:67], 0
    s_nop 0
    v_mfma_f32_16x16x32_bf16 a[4:7], v[240:243], v[68:71], 0
    v_accvgpr_read_b32 v56, a161
    v_accvgpr_read_b32 v57, a165
    v_accvgpr_read_b32 v58, a169
    v_accvgpr_read_b32 v59, a173
    v_accvgpr_read_b32 v60, a177
    v_accvgpr_read_b32 v61, a181
    v_accvgpr_read_b32 v62, a185
    v_accvgpr_read_b32 v63, a189
    v_perm_b32 v72, v57, v56, s74
    v_perm_b32 v73, v59, v58, s74
    v_perm_b32 v74, v61, v60, s74
    v_perm_b32 v75, v63, v62, s74
    v_perm_b32 v76, v57, v56, s75
    v_perm_b32 v77, v59, v58, s75
    v_perm_b32 v78, v61, v60, s75
    v_perm_b32 v79, v63, v62, s75
    v_mfma_f32_16x16x32_bf16 a[8:11], v[240:243], v[72:75], 0
    s_nop 0
    v_mfma_f32_16x16x32_bf16 a[12:15], v[240:243], v[76:79], 0
    v_accvgpr_read_b32 v48, a162
    v_accvgpr_read_b32 v49, a166
    v_accvgpr_read_b32 v50, a170
    v_accvgpr_read_b32 v51, a174
    v_accvgpr_read_b32 v52, a178
    v_accvgpr_read_b32 v53, a182
    v_accvgpr_read_b32 v54, a186
    v_accvgpr_read_b32 v55, a190
    v_perm_b32 v64, v49, v48, s74
    v_perm_b32 v65, v51, v50, s74
    v_perm_b32 v66, v53, v52, s74
    v_perm_b32 v67, v55, v54, s74
    v_perm_b32 v68, v49, v48, s75
    v_perm_b32 v69, v51, v50, s75
    v_perm_b32 v70, v53, v52, s75
    v_perm_b32 v71, v55, v54, s75
    v_mfma_f32_16x16x32_bf16 a[16:19], v[240:243], v[64:67], 0
    s_nop 0
    v_mfma_f32_16x16x32_bf16 a[20:23], v[240:243], v[68:71], 0
    v_accvgpr_read_b32 v56, a163
    v_accvgpr_read_b32 v57, a167
    v_accvgpr_read_b32 v58, a171
    v_accvgpr_read_b32 v59, a175
    v_accvgpr_read_b32 v60, a179
    v_accvgpr_read_b32 v61, a183
    v_accvgpr_read_b32 v62, a187
    v_accvgpr_read_b32 v63, a191
    v_perm_b32 v72, v57, v56, s74
    v_perm_b32 v73, v59, v58, s74
    v_perm_b32 v74, v61, v60, s74
    v_perm_b32 v75, v63, v62, s74
    v_perm_b32 v76, v57, v56, s75
    v_perm_b32 v77, v59, v58, s75
    v_perm_b32 v78, v61, v60, s75
    v_perm_b32 v79, v63, v62, s75
    v_mfma_f32_16x16x32_bf16 a[24:27], v[240:243], v[72:75], 0
    s_nop 0
    v_mfma_f32_16x16x32_bf16 a[28:31], v[240:243], v[76:79], 0
    s_waitcnt vmcnt(8)
    s_cbranch_vccnz L_w81
    s_waitcnt vmcnt(5)
L_w81:
    buffer_load_dwordx4 v[140:143], v14, s[32:35], s79 offen offset:2048 nt
    s_add_u32 s79, s71, 131072
    s_waitcnt vmcnt(8)
    s_cbranch_vccnz L_w82
    s_waitcnt vmcnt(5)
L_w82:
    buffer_load_dwordx4 v[144:147], v14, s[32:35], s79 offen offset:256 nt
    s_waitcnt lgkmcnt(0)
    s_barrier
    ds_read_b128 v[48:51], v18 offset:16
    ds_read_b128 v[52:55], v18 offset:64
    s_waitcnt lgkmcnt(0)
    v_max3_f32 v16, v48, v49, v50
    v_max_f32 v16, v16, v51
    v_sub_f32 v48, v48, v16
    v_sub_f32 v49, v49, v16
    v_sub_f32 v50, v50, v16
    v_sub_f32 v51, v51, v16
    v_exp_f32 v48, v48
    v_exp_f32 v49, v49
    v_exp_f32 v50, v50
    v_exp_f32 v51, v51
    v_mul_f32 v17, v48, v52
    v_fmac_f32 v17, v49, v53
    v_fmac_f32 v17, v50, v54
    v_fmac_f32 v17, v51, v55
    s_lshr_b32 s100, s3, 1
    v_readlane_b32 s36, v48, s100
    v_readlane_b32 s37, v49, s100
    v_readlane_b32 s38, v50, s100
    v_readlane_b32 s39, v51, s100
    v_and_b32 v23, 2, v1
    v_cmp_eq_u32 vcc, 0, v23
    s_nop 1
    v_cndmask_b32 v60, v17, v16, vcc
    v_mov_b32 v61, s72
    s_lshl_b32 s100, s2, 5
    s_add_u32 s100, s100, 917504
    v_lshlrev_b32 v23, 3, v1
    v_add_u32 v23, s100, v23
    s_cmp_eq_u32 s3, 0
    s_cbranch_scc0 L_nostat
    s_mov_b64 exec, 0xf
    global_store_dwordx2 v23, v[60:61], s[26:27] sc1
    s_mov_b64 exec, -1
L_nostat:
    s_mov_b64 vcc, s[62:63]
    s_waitcnt vmcnt(8)
    s_cbranch_vccnz L_w83
    s_waitcnt vmcnt(5)
L_w83:
    buffer_load_dwordx4 v[148:151], v14, s[32:35], s79 offen offset:2304 nt
    s_add_u32 s79, s71, 135168
    s_waitcnt vmcnt(8)
    s_cbranch_vccnz L_w84
    s_waitcnt vmcnt(5)
L_w84:
    buffer_load_dwordx4 v[152:155], v14, s[32:35], s79 offen offset:256 nt
    v_accvgpr_read_b32 v48, a192
    v_accvgpr_read_b32 v49, a196
    v_accvgpr_read_b32 v50, a200
    v_accvgpr_read_b32 v51, a204
    v_accvgpr_read_b32 v52, a208
    v_accvgpr_read_b32 v53, a212
    v_accvgpr_read_b32 v54, a216
    v_accvgpr_read_b32 v55, a220
    v_perm_b32 v64, v49, v48, s74
    v_perm_b32 v65, v51, v50, s74
    v_perm_b32 v66, v53, v52, s74
    v_perm_b32 v67, v55, v54, s74
    v_perm_b32 v68, v49, v48, s75
    v_perm_b32 v69, v51, v50, s75
    v_perm_b32 v70, v53, v52, s75
    v_perm_b32 v71, v55, v54, s75
    v_mfma_f32_16x16x32_bf16 a[32:35], v[240:243], v[64:67], 0
    s_nop 0
    v_mfma_f32_16x16x32_bf16 a[36:39], v[240:243], v[68:71], 0
    v_accvgpr_read_b32 v56, a193
    v_accvgpr_read_b32 v57, a197
    v_accvgpr_read_b32 v58, a201
    v_accvgpr_read_b32 v59, a205
    v_accvgpr_read_b32 v60, a209
    v_accvgpr_read_b32 v61, a213
    v_accvgpr_read_b32 v62, a217
    v_accvgpr_read_b32 v63, a221
    v_perm_b32 v72, v57, v56, s74
    v_perm_b32 v73, v59, v58, s74
    v_perm_b32 v74, v61, v60, s74
    v_perm_b32 v75, v63, v62, s74
    v_perm_b32 v76, v57, v56, s75
    v_perm_b32 v77, v59, v58, s75
    v_perm_b32 v78, v61, v60, s75
    v_perm_b32 v79, v63, v62, s75
    v_mfma_f32_16x16x32_bf16 a[40:43], v[240:243], v[72:75], 0
    s_nop 0
    v_mfma_f32_16x16x32_bf16 a[44:47], v[240:243], v[76:79], 0
    v_accvgpr_read_b32 v48, a194
    v_accvgpr_read_b32 v49, a198
    v_accvgpr_read_b32 v50, a202
    v_accvgpr_read_b32 v51, a206
    v_accvgpr_read_b32 v52, a210
    v_accvgpr_read_b32 v53, a214
    v_accvgpr_read_b32 v54, a218
    v_accvgpr_read_b32 v55, a222
    v_perm_b32 v64, v49, v48, s74
    v_perm_b32 v65, v51, v50, s74
    v_perm_b32 v66, v53, v52, s74
    v_perm_b32 v67, v55, v54, s74
    v_perm_b32 v68, v49, v48, s75
    v_perm_b32 v69, v51, v50, s75
    v_perm_b32 v70, v53, v52, s75
    v_perm_b32 v71, v55, v54, s75
    v_mfma_f32_16x16x32_bf16 a[48:51], v[240:243], v[64:67], 0
    s_nop 0
    v_mfma_f32_16x16x32_bf16 a[52:55], v[240:243], v[68:71], 0
    v_accvgpr_read_b32 v56, a195
    v_accvgpr_read_b32 v57, a199
    v_accvgpr_read_b32 v58, a203
    v_accvgpr_read_b32 v59, a207
    v_accvgpr_read_b32 v60, a211
    v_accvgpr_read_b32 v61, a215
    v_accvgpr_read_b32 v62, a219
    v_accvgpr_read_b32 v63, a223
    v_perm_b32 v72, v57, v56, s74
    v_perm_b32 v73, v59, v58, s74
    v_perm_b32 v74, v61, v60, s74
    v_perm_b32 v75, v63, v62, s74
    v_perm_b32 v76, v57, v56, s75
    v_perm_b32 v77, v59, v58, s75
    v_perm_b32 v78, v61, v60, s75
    v_perm_b32 v79, v63, v62, s75
    v_mfma_f32_16x16x32_bf16 a[56:59], v[240:243], v[72:75], 0
    s_nop 0
    v_mfma_f32_16x16x32_bf16 a[60:63], v[240:243], v[76:79], 0
    s_waitcnt vmcnt(8)
    s_cbranch_vccnz L_w85
    s_waitcnt vmcnt(5)
L_w85:
    buffer_load_dwordx4 v[156:159], v14, s[32:35], s79 offen offset:2304 nt
    s_add_u32 s79, s71, 163840
    s_waitcnt vmcnt(8)
    s_cbranch_vccnz L_w86
    s_waitcnt vmcnt(5)
L_w86:
    buffer_load_dwordx4 v[160:163], v14, s[32:35], s79 offen offset:256 nt
    v_accvgpr_read_b32 v48, a224
    v_accvgpr_read_b32 v49, a228
    v_accvgpr_read_b32 v50, a232
    v_accvgpr_read_b32 v51, a236
    v_accvgpr_read_b32 v52, a240
    v_accvgpr_read_b32 v53, a244
    v_accvgpr_read_b32 v54, a248
    v_accvgpr_read_b32 v55, a252
    v_perm_b32 v64, v49, v48, s74
    v_perm_b32 v65, v51, v50, s74
    v_perm_b32 v66, v53, v52, s74
    v_perm_b32 v67, v55, v54, s74
    v_perm_b32 v68, v49, v48, s75
    v_perm_b32 v69, v51, v50, s75
    v_perm_b32 v70, v53, v52, s75
    v_perm_b32 v71, v55, v54, s75
    v_mfma_f32_16x16x32_bf16 a[0:3], v[244:247], v[64:67], a[0:3]
    s_nop 0
    v_mfma_f32_16x16x32_bf16 a[4:7], v[244:247], v[68:71], a[4:7]
    v_accvgpr_read_b32 v56, a225
    v_accvgpr_read_b32 v57, a229
    v_accvgpr_read_b32 v58, a233
    v_accvgpr_read_b32 v59, a237
    v_accvgpr_read_b32 v60, a241
    v_accvgpr_read_b32 v61, a245
    v_accvgpr_read_b32 v62, a249
    v_accvgpr_read_b32 v63, a253
    v_perm_b32 v72, v57, v56, s74
    v_perm_b32 v73, v59, v58, s74
    v_perm_b32 v74, v61, v60, s74
    v_perm_b32 v75, v63, v62, s74
    v_perm_b32 v76, v57, v56, s75
    v_perm_b32 v77, v59, v58, s75
    v_perm_b32 v78, v61, v60, s75
    v_perm_b32 v79, v63, v62, s75
    v_mfma_f32_16x16x32_bf16 a[8:11], v[244:247], v[72:75], a[8:11]
    s_nop 0
    v_mfma_f32_16x16x32_bf16 a[12:15], v[244:247], v[76:79], a[12:15]
    v_accvgpr_read_b32 v48, a226
    v_accvgpr_read_b32 v49, a230
    v_accvgpr_read_b32 v50, a234
    v_accvgpr_read_b32 v51, a238
    v_accvgpr_read_b32 v52, a242
    v_accvgpr_read_b32 v53, a246
    v_accvgpr_read_b32 v54, a250
    v_accvgpr_read_b32 v55, a254
    v_perm_b32 v64, v49, v48, s74
    v_perm_b32 v65, v51, v50, s74
    v_perm_b32 v66, v53, v52, s74
    v_perm_b32 v67, v55, v54, s74
    v_perm_b32 v68, v49, v48, s75
    v_perm_b32 v69, v51, v50, s75
    v_perm_b32 v70, v53, v52, s75
    v_perm_b32 v71, v55, v54, s75
    v_mfma_f32_16x16x32_bf16 a[16:19], v[244:247], v[64:67], a[16:19]
    s_nop 0
    v_mfma_f32_16x16x32_bf16 a[20:23], v[244:247], v[68:71], a[20:23]
    v_accvgpr_read_b32 v56, a227
    v_accvgpr_read_b32 v57, a231
    v_accvgpr_read_b32 v58, a235
    v_accvgpr_read_b32 v59, a239
    v_accvgpr_read_b32 v60, a243
    v_accvgpr_read_b32 v61, a247
    v_accvgpr_read_b32 v62, a251
    v_accvgpr_read_b32 v63, a255
    v_perm_b32 v72, v57, v56, s74
    v_perm_b32 v73, v59, v58, s74
    v_perm_b32 v74, v61, v60, s74
    v_perm_b32 v75, v63, v62, s74
    v_perm_b32 v76, v57, v56, s75
    v_perm_b32 v77, v59, v58, s75
    v_perm_b32 v78, v61, v60, s75
    v_perm_b32 v79, v63, v62, s75
    v_mfma_f32_16x16x32_bf16 a[24:27], v[244:247], v[72:75], a[24:27]
    s_nop 0
    v_mfma_f32_16x16x32_bf16 a[28:31], v[244:247], v[76:79], a[28:31]
    s_waitcnt vmcnt(8)
    s_cbranch_vccnz L_w87
    s_waitcnt vmcnt(5)
L_w87:
    buffer_load_dwordx4 v[164:167], v14, s[32:35], s79 offen offset:2304 nt
    s_add_u32 s79, s71, 167936
    s_waitcnt vmcnt(8)
    s_cbranch_vccnz L_w88
    s_waitcnt vmcnt(5)
L_w88:
    buffer_load_dwordx4 v[168:171], v14, s[32:35], s79 offen offset:256 nt
    s_waitcnt vmcnt(8)
    s_cbranch_vccnz L_w89
    s_waitcnt vmcnt(5)
L_w89:
    buffer_load_dwordx4 v[172:175], v14, s[32:35], s79 offen offset:2304 nt
    s_add_u32 s79, s71, 196608
    s_waitcnt vmcnt(8)
    s_cbranch_vccnz L_w90
    s_waitcnt vmcnt(5)
L_w90:
    buffer_load_dwordx4 v[176:179], v14, s[32:35], s79 offen offset:0 nt
    v_perm_b32 v64, v84, v80, s74
    v_perm_b32 v65, v92, v88, s74
    v_perm_b32 v66, v100, v96, s74
    v_perm_b32 v67, v108, v104, s74
    v_perm_b32 v68, v84, v80, s75
    v_perm_b32 v69, v92, v88, s75
    v_perm_b32 v70, v100, v96, s75
    v_perm_b32 v71, v108, v104, s75
    v_mfma_f32_16x16x32_bf16 a[32:35], v[244:247], v[64:67], a[32:35]
    s_nop 0
    v_mfma_f32_16x16x32_bf16 a[36:39], v[244:247], v[68:71], a[36:39]
    v_perm_b32 v72, v85, v81, s74
    v_perm_b32 v73, v93, v89, s74
    v_perm_b32 v74, v101, v97, s74
    v_perm_b32 v75, v109, v105, s74
    v_perm_b32 v76, v85, v81, s75
    v_perm_b32 v77, v93, v89, s75
    v_perm_b32 v78, v101, v97, s75
    v_perm_b32 v79, v109, v105, s75
    v_mfma_f32_16x16x32_bf16 a[40:43], v[244:247], v[72:75], a[40:43]
    s_nop 0
    v_mfma_f32_16x16x32_bf16 a[44:47], v[244:247], v[76:79], a[44:47]
    v_perm_b32 v64, v86, v82, s74
    v_perm_b32 v65, v94, v90, s74
    v_perm_b32 v66, v102, v98, s74
    v_perm_b32 v67, v110, v106, s74
    v_perm_b32 v68, v86, v82, s75
    v_perm_b32 v69, v94, v90, s75
    v_perm_b32 v70, v102, v98, s75
    v_perm_b32 v71, v110, v106, s75
    v_mfma_f32_16x16x32_bf16 a[48:51], v[244:247], v[64:67], a[48:51]
    s_nop 0
    v_mfma_f32_16x16x32_bf16 a[52:55], v[244:247], v[68:71], a[52:55]
    v_perm_b32 v72, v87, v83, s74
    v_perm_b32 v73, v95, v91, s74
    v_perm_b32 v74, v103, v99, s74
    v_perm_b32 v75, v111, v107, s74
    v_perm_b32 v76, v87, v83, s75
    v_perm_b32 v77, v95, v91, s75
    v_perm_b32 v78, v103, v99, s75
    v_perm_b32 v79, v111, v107, s75
    v_mfma_f32_16x16x32_bf16 a[56:59], v[244:247], v[72:75], a[56:59]
    s_nop 0
    v_mfma_f32_16x16x32_bf16 a[60:63], v[244:247], v[76:79], a[60:63]
    s_waitcnt vmcnt(8)
    s_cbranch_vccnz L_w91
    s_waitcnt vmcnt(5)
L_w91:
    buffer_load_dwordx4 v[180:183], v14, s[32:35], s79 offen offset:2048 nt
    s_add_u32 s79, s71, 200704
    s_waitcnt vmcnt(8)
    s_cbranch_vccnz L_w92
    s_waitcnt vmcnt(5)
L_w92:
    buffer_load_dwordx4 v[184:187], v14, s[32:35], s79 offen offset:0 nt
    s_waitcnt vmcnt(8)
    s_cbranch_vccnz L_w93
    s_waitcnt vmcnt(5)
L_w93:
    buffer_load_dwordx4 v[188:191], v14, s[32:35], s79 offen offset:2048 nt
    s_add_u32 s79, s71, 229376
    s_waitcnt vmcnt(8)
    s_cbranch_vccnz L_w94
    s_waitcnt vmcnt(5)
L_w94:
    buffer_load_dwordx4 v[192:195], v14, s[32:35], s79 offen offset:0 nt
    s_waitcnt vmcnt(8)
    s_cbranch_vccnz L_w95
    s_waitcnt vmcnt(5)
L_w95:
    buffer_load_dwordx4 v[196:199], v14, s[32:35], s79 offen offset:2048 nt
    s_add_u32 s79, s71, 233472
    s_waitcnt vmcnt(8)
    s_cbranch_vccnz L_w96
    s_waitcnt vmcnt(5)
L_w96:
    buffer_load_dwordx4 v[200:203], v14, s[32:35], s79 offen offset:0 nt
    s_waitcnt vmcnt(8)
    s_cbranch_vccnz L_w97
    s_waitcnt vmcnt(5)
L_w97:
    buffer_load_dwordx4 v[204:207], v14, s[32:35], s79 offen offset:2048 nt
    s_add_u32 s79, s71, 196608
    s_waitcnt vmcnt(8)
    s_cbranch_vccnz L_w98
    s_waitcnt vmcnt(5)
L_w98:
    buffer_load_dwordx4 v[208:211], v14, s[32:35], s79 offen offset:256 nt
    s_waitcnt vmcnt(8)
    s_cbranch_vccnz L_w99
    s_waitcnt vmcnt(5)
L_w99:
    buffer_load_dwordx4 v[212:215], v14, s[32:35], s79 offen offset:2304 nt
    s_add_u32 s79, s71, 200704
    s_waitcnt vmcnt(8)
    s_cbranch_vccnz L_w100
    s_waitcnt vmcnt(5)
L_w100:
    buffer_load_dwordx4 v[216:219], v14, s[32:35], s79 offen offset:256 nt
    s_waitcnt vmcnt(8)
    s_cbranch_vccnz L_w101
    s_waitcnt vmcnt(5)
L_w101:
    buffer_load_dwordx4 v[220:223], v14, s[32:35], s79 offen offset:2304 nt
    s_add_u32 s79, s71, 229376
    s_waitcnt vmcnt(8)
    s_cbranch_vccnz L_w102
    s_waitcnt vmcnt(5)
L_w102:
    buffer_load_dwordx4 v[224:227], v14, s[32:35], s79 offen offset:256 nt
    s_waitcnt vmcnt(8)
    s_cbranch_vccnz L_w103
    s_waitcnt vmcnt(5)
L_w103:
    buffer_load_dwordx4 v[228:231], v14, s[32:35], s79 offen offset:2304 nt
    s_add_u32 s79, s71, 233472
    s_waitcnt vmcnt(8)
    s_cbranch_vccnz L_w104
    s_waitcnt vmcnt(5)
L_w104:
    buffer_load_dwordx4 v[232:235], v14, s[32:35], s79 offen offset:256 nt
    s_waitcnt vmcnt(8)
    s_cbranch_vccnz L_w105
    s_waitcnt vmcnt(5)
L_w105:
    buffer_load_dwordx4 v[236:239], v14, s[32:35], s79 offen offset:2304 nt
    s_lshl_b32 s100, s3, 12
    s_add_u32 m0, s100, 131072
    s_nop 0
    buffer_load_dwordx4 v15, s[44:47], s78 offen nt lds
    s_lshl_b32 s100, s3, 12
    s_add_u32 m0, s100, 132096
    s_add_u32 s78, s78, 7168
    buffer_load_dwordx4 v15, s[44:47], s78 offen nt lds
    s_lshl_b32 s100, s3, 12
    s_add_u32 m0, s100, 133120
    s_add_u32 s78, s78, 7168
    buffer_load_dwordx4 v15, s[44:47], s78 offen nt lds
    s_lshl_b32 s100, s3, 12
    s_add_u32 m0, s100, 134144
    s_add_u32 s78, s78, 7168
    buffer_load_dwordx4 v15, s[44:47], s78 offen nt lds
    s_lshl_b32 s100, s3, 11
    s_add_u32 m0, s100, 147456
    s_nop 0
    buffer_load_dwordx4 v15, s[48:51], s53 offen nt lds
    s_lshl_b32 s100, s3, 11
    s_add_u32 m0, s100, 148480
    s_add_u32 s53, s53, 7168
    buffer_load_dwordx4 v15, s[48:51], s53 offen nt lds
    s_mov_b32 s28, s20
    s_and_b32 s29, s21, 0xffff
    s_mov_b32 s30, 896
    s_mov_b32 s31, 0x20000
    s_mul_i32 s69, s3, 896
    s_add_u32 s40, s4, s69
    s_addc_u32 s41, s5, 0
    s_and_b32 s41, s41, 0xffff
    s_mov_b32 s42, 896
    s_mov_b32 s43, 0x20000
    v_lshlrev_b32 v23, 4, v1
    buffer_load_dwordx4 v[2:5], v23, s[40:43], 0 offen nt
    buffer_load_dwordx4 v[6:9], v23, s[28:31], 0 offen nt
    v_perm_b32 v64, v116, v112, s74
    v_perm_b32 v65, v124, v120, s74
    v_perm_b32 v66, v132, v128, s74
    v_perm_b32 v67, v140, v136, s74
    v_perm_b32 v68, v116, v112, s75
    v_perm_b32 v69, v124, v120, s75
    v_perm_b32 v70, v132, v128, s75
    v_perm_b32 v71, v140, v136, s75
    v_mfma_f32_16x16x32_bf16 a[0:3], v[248:251], v[64:67], a[0:3]
    s_nop 0
    v_mfma_f32_16x16x32_bf16 a[4:7], v[248:251], v[68:71], a[4:7]
    v_perm_b32 v72, v117, v113, s74
    v_perm_b32 v73, v125, v121, s74
    v_perm_b32 v74, v133, v129, s74
    v_perm_b32 v75, v141, v137, s74
    v_perm_b32 v76, v117, v113, s75
    v_perm_b32 v77, v125, v121, s75
    v_perm_b32 v78, v133, v129, s75
    v_perm_b32 v79, v141, v137, s75
    v_mfma_f32_16x16x32_bf16 a[8:11], v[248:251], v[72:75], a[8:11]
    s_nop 0
    v_mfma_f32_16x16x32_bf16 a[12:15], v[248:251], v[76:79], a[12:15]
    v_perm_b32 v64, v118, v114, s74
    v_perm_b32 v65, v126, v122, s74
    v_perm_b32 v66, v134, v130, s74
    v_perm_b32 v67, v142, v138, s74
    v_perm_b32 v68, v118, v114, s75
    v_perm_b32 v69, v126, v122, s75
    v_perm_b32 v70, v134, v130, s75
    v_perm_b32 v71, v142, v138, s75
    v_mfma_f32_16x16x32_bf16 a[16:19], v[248:251], v[64:67], a[16:19]
    s_nop 0
    v_mfma_f32_16x16x32_bf16 a[20:23], v[248:251], v[68:71], a[20:23]
    v_perm_b32 v72, v119, v115, s74
    v_perm_b32 v73, v127, v123, s74
    v_perm_b32 v74, v135, v131, s74
    v_perm_b32 v75, v143, v139, s74
    v_perm_b32 v76, v119, v115, s75
    v_perm_b32 v77, v127, v123, s75
    v_perm_b32 v78, v135, v131, s75
    v_perm_b32 v79, v143, v139, s75
    v_mfma_f32_16x16x32_bf16 a[24:27], v[248:251], v[72:75], a[24:27]
    s_nop 0
    v_mfma_f32_16x16x32_bf16 a[28:31], v[248:251], v[76:79], a[28:31]
    v_perm_b32 v64, v148, v144, s74
    v_perm_b32 v65, v156, v152, s74
    v_perm_b32 v66, v164, v160, s74
    v_perm_b32 v67, v172, v168, s74
    v_perm_b32 v68, v148, v144, s75
    v_perm_b32 v69, v156, v152, s75
    v_perm_b32 v70, v164, v160, s75
    v_perm_b32 v71, v172, v168, s75
    v_mfma_f32_16x16x32_bf16 a[32:35], v[248:251], v[64:67], a[32:35]
    s_nop 0
    v_mfma_f32_16x16x32_bf16 a[36:39], v[248:251], v[68:71], a[36:39]
    v_perm_b32 v72, v149, v145, s74
    v_perm_b32 v73, v157, v153, s74
    v_perm_b32 v74, v165, v161, s74
    v_perm_b32 v75, v173, v169, s74
    v_perm_b32 v76, v149, v145, s75
    v_perm_b32 v77, v157, v153, s75
    v_perm_b32 v78, v165, v161, s75
    v_perm_b32 v79, v173, v169, s75
    v_mfma_f32_16x16x32_bf16 a[40:43], v[248:251], v[72:75], a[40:43]
    s_nop 0
    v_mfma_f32_16x16x32_bf16 a[44:47], v[248:251], v[76:79], a[44:47]
    v_perm_b32 v64, v150, v146, s74
    v_perm_b32 v65, v158, v154, s74
    v_perm_b32 v66, v166, v162, s74
    v_perm_b32 v67, v174, v170, s74
    v_perm_b32 v68, v150, v146, s75
    v_perm_b32 v69, v158, v154, s75
    v_perm_b32 v70, v166, v162, s75
    v_perm_b32 v71, v174, v170, s75
    v_mfma_f32_16x16x32_bf16 a[48:51], v[248:251], v[64:67], a[48:51]
    s_nop 0
    v_mfma_f32_16x16x32_bf16 a[52:55], v[248:251], v[68:71], a[52:55]
    v_perm_b32 v72, v151, v147, s74
    v_perm_b32 v73, v159, v155, s74
    v_perm_b32 v74, v167, v163, s74
    v_perm_b32 v75, v175, v171, s74
    v_perm_b32 v76, v151, v147, s75
    v_perm_b32 v77, v159, v155, s75
    v_perm_b32 v78, v167, v163, s75
    v_perm_b32 v79, v175, v171, s75
    v_mfma_f32_16x16x32_bf16 a[56:59], v[248:251], v[72:75], a[56:59]
    s_nop 0
    v_mfma_f32_16x16x32_bf16 a[60:63], v[248:251], v[76:79], a[60:63]
    s_waitcnt vmcnt(16)
    v_perm_b32 v64, v180, v176, s74
    v_perm_b32 v65, v188, v184, s74
    v_perm_b32 v66, v196, v192, s74
    v_perm_b32 v67, v204, v200, s74
    v_perm_b32 v68, v180, v176, s75
    v_perm_b32 v69, v188, v184, s75
    v_perm_b32 v70, v196, v192, s75
    v_perm_b32 v71, v204, v200, s75
    v_mfma_f32_16x16x32_bf16 a[0:3], v[252:255], v[64:67], a[0:3]
    s_nop 0
    v_mfma_f32_16x16x32_bf16 a[4:7], v[252:255], v[68:71], a[4:7]
    v_perm_b32 v72, v181, v177, s74
    v_perm_b32 v73, v189, v185, s74
    v_perm_b32 v74, v197, v193, s74
    v_perm_b32 v75, v205, v201, s74
    v_perm_b32 v76, v181, v177, s75
    v_perm_b32 v77, v189, v185, s75
    v_perm_b32 v78, v197, v193, s75
    v_perm_b32 v79, v205, v201, s75
    v_mfma_f32_16x16x32_bf16 a[8:11], v[252:255], v[72:75], a[8:11]
    s_nop 0
    v_mfma_f32_16x16x32_bf16 a[12:15], v[252:255], v[76:79], a[12:15]
    v_perm_b32 v64, v182, v178, s74
    v_perm_b32 v65, v190, v186, s74
    v_perm_b32 v66, v198, v194, s74
    v_perm_b32 v67, v206, v202, s74
    v_perm_b32 v68, v182, v178, s75
    v_perm_b32 v69, v190, v186, s75
    v_perm_b32 v70, v198, v194, s75
    v_perm_b32 v71, v206, v202, s75
    v_mfma_f32_16x16x32_bf16 a[16:19], v[252:255], v[64:67], a[16:19]
    s_nop 0
    v_mfma_f32_16x16x32_bf16 a[20:23], v[252:255], v[68:71], a[20:23]
    v_perm_b32 v72, v183, v179, s74
    v_perm_b32 v73, v191, v187, s74
    v_perm_b32 v74, v199, v195, s74
    v_perm_b32 v75, v207, v203, s74
    v_perm_b32 v76, v183, v179, s75
    v_perm_b32 v77, v191, v187, s75
    v_perm_b32 v78, v199, v195, s75
    v_perm_b32 v79, v207, v203, s75
    v_mfma_f32_16x16x32_bf16 a[24:27], v[252:255], v[72:75], a[24:27]
    s_nop 0
    v_mfma_f32_16x16x32_bf16 a[28:31], v[252:255], v[76:79], a[28:31]
    s_mov_b64 exec, 0xffff
    ds_write_b64 v32, a[0:1] offset:0
    ds_write_b64 v32, a[4:5] offset:128
    ds_write_b64 v32, a[8:9] offset:256
    ds_write_b64 v32, a[12:13] offset:384
    ds_write_b64 v32, a[16:17] offset:512
    ds_write_b64 v32, a[20:21] offset:640
    ds_write_b64 v32, a[24:25] offset:768
    ds_write_b64 v32, a[28:29] offset:896
    s_mov_b64 exec, -1
    s_waitcnt vmcnt(8)
    v_perm_b32 v64, v212, v208, s74
    v_perm_b32 v65, v220, v216, s74
    v_perm_b32 v66, v228, v224, s74
    v_perm_b32 v67, v236, v232, s74
    v_perm_b32 v68, v212, v208, s75
    v_perm_b32 v69, v220, v216, s75
    v_perm_b32 v70, v228, v224, s75
    v_perm_b32 v71, v236, v232, s75
    v_mfma_f32_16x16x32_bf16 a[32:35], v[252:255], v[64:67], a[32:35]
    s_nop 0
    v_mfma_f32_16x16x32_bf16 a[36:39], v[252:255], v[68:71], a[36:39]
    v_perm_b32 v72, v213, v209, s74
    v_perm_b32 v73, v221, v217, s74
    v_perm_b32 v74, v229, v225, s74
    v_perm_b32 v75, v237, v233, s74
    v_perm_b32 v76, v213, v209, s75
    v_perm_b32 v77, v221, v217, s75
    v_perm_b32 v78, v229, v225, s75
    v_perm_b32 v79, v237, v233, s75
    v_mfma_f32_16x16x32_bf16 a[40:43], v[252:255], v[72:75], a[40:43]
    s_nop 0
    v_mfma_f32_16x16x32_bf16 a[44:47], v[252:255], v[76:79], a[44:47]
    v_perm_b32 v64, v214, v210, s74
    v_perm_b32 v65, v222, v218, s74
    v_perm_b32 v66, v230, v226, s74
    v_perm_b32 v67, v238, v234, s74
    v_perm_b32 v68, v214, v210, s75
    v_perm_b32 v69, v222, v218, s75
    v_perm_b32 v70, v230, v226, s75
    v_perm_b32 v71, v238, v234, s75
    v_mfma_f32_16x16x32_bf16 a[48:51], v[252:255], v[64:67], a[48:51]
    s_nop 0
    v_mfma_f32_16x16x32_bf16 a[52:55], v[252:255], v[68:71], a[52:55]
    v_perm_b32 v72, v215, v211, s74
    v_perm_b32 v73, v223, v219, s74
    v_perm_b32 v74, v231, v227, s74
    v_perm_b32 v75, v239, v235, s74
    v_perm_b32 v76, v215, v211, s75
    v_perm_b32 v77, v223, v219, s75
    v_perm_b32 v78, v231, v227, s75
    v_perm_b32 v79, v239, v235, s75
    v_mfma_f32_16x16x32_bf16 a[56:59], v[252:255], v[72:75], a[56:59]
    s_nop 0
    v_mfma_f32_16x16x32_bf16 a[60:63], v[252:255], v[76:79], a[60:63]
    s_mov_b64 exec, 0xffff
    ds_write_b64 v32, a[32:33] offset:1024
    ds_write_b64 v32, a[36:37] offset:1152
    ds_write_b64 v32, a[40:41] offset:1280
    ds_write_b64 v32, a[44:45] offset:1408
    ds_write_b64 v32, a[48:49] offset:1536
    ds_write_b64 v32, a[52:53] offset:1664
    ds_write_b64 v32, a[56:57] offset:1792
    ds_write_b64 v32, a[60:61] offset:1920
    s_mov_b64 exec, -1
    s_waitcnt lgkmcnt(0)
    s_barrier
    ds_read_b32 v80, v33 offset:0
    ds_read_b32 v81, v33 offset:128
    ds_read_b32 v82, v33 offset:32768
    ds_read_b32 v83, v33 offset:32896
    ds_read_b32 v84, v34 offset:0
    ds_read_b32 v85, v34 offset:128
    ds_read_b32 v86, v34 offset:32768
    ds_read_b32 v87, v34 offset:32896
    s_waitcnt lgkmcnt(6)
    v_mul_f32 v88, s36, v80
    v_mul_f32 v89, s36, v81
    s_waitcnt lgkmcnt(4)
    v_fmac_f32 v88, s37, v82
    v_fmac_f32 v89, s37, v83
    s_waitcnt lgkmcnt(2)
    v_fmac_f32 v88, s38, v84
    v_fmac_f32 v89, s38, v85
    s_waitcnt lgkmcnt(0)
    v_fmac_f32 v88, s39, v86
    v_fmac_f32 v89, s39, v87
    v_cvt_pk_bf16_f32 v44, v88, v89
    global_store_dwordx2 v35, v[44:45], s[26:27] sc1
    s_cmp_eq_u32 s68, 7
    s_cbranch_scc1 L_fin
    global_load_dwordx2 v[112:113], v38, s[26:27] sc1
    global_load_dwordx2 v[96:97], v36, s[26:27] offset:-4096 sc1
    global_load_dwordx2 v[98:99], v36, s[26:27] offset:-2048 sc1
    global_load_dwordx2 v[100:101], v36, s[26:27] offset:0 sc1
    global_load_dwordx2 v[102:103], v36, s[26:27] offset:2048 sc1
    global_load_dwordx2 v[104:105], v37, s[26:27] offset:-4096 sc1
    global_load_dwordx2 v[106:107], v37, s[26:27] offset:-2048 sc1
    global_load_dwordx2 v[108:109], v37, s[26:27] offset:0 sc1
    global_load_dwordx2 v[110:111], v37, s[26:27] offset:2048 sc1
    s_waitcnt vmcnt(10)
    v_mov_b32 v128, 0
    v_lshlrev_b32 v129, 16, v2
    v_lshlrev_b32 v130, 16, v6
    v_and_b32 v131, 0xffff0000, v2
    v_and_b32 v136, 0xffff0000, v6
    v_fmac_f32 v128, v129, v130
    v_fmac_f32 v128, v131, v136
    v_lshlrev_b32 v129, 16, v3
    v_lshlrev_b32 v130, 16, v7
    v_and_b32 v131, 0xffff0000, v3
    v_and_b32 v136, 0xffff0000, v7
    v_fmac_f32 v128, v129, v130
    v_fmac_f32 v128, v131, v136
    v_lshlrev_b32 v129, 16, v4
    v_lshlrev_b32 v130, 16, v8
    v_and_b32 v131, 0xffff0000, v4
    v_and_b32 v136, 0xffff0000, v8
    v_fmac_f32 v128, v129, v130
    v_fmac_f32 v128, v131, v136
    v_lshlrev_b32 v129, 16, v5
    v_lshlrev_b32 v130, 16, v9
    v_and_b32 v131, 0xffff0000, v5
    v_and_b32 v136, 0xffff0000, v9
    v_fmac_f32 v128, v129, v130
    v_fmac_f32 v128, v131, v136
    s_nop 1
    v_add_f32_dpp v128, v128, v128 row_ror:8 row_mask:0xf bank_mask:0xf
    s_nop 1
    v_add_f32_dpp v128, v128, v128 row_ror:4 row_mask:0xf bank_mask:0xf
    s_nop 1
    v_add_f32_dpp v128, v128, v128 row_ror:2 row_mask:0xf bank_mask:0xf
    s_nop 1
    v_add_f32_dpp v128, v128, v128 row_ror:1 row_mask:0xf bank_mask:0xf
    v_mov_b32 v129, v128
    s_nop 1
    v_permlane16_swap_b32 v128, v129
    v_add_f32 v128, v128, v129
    v_mov_b32 v129, v128
    s_nop 1
    v_permlane32_swap_b32 v128, v129
    v_add_f32 v128, v128, v129
    v_mul_f32 v128, 0xbfb8aa3b, v128
    v_exp_f32 v128, v128
    s_nop 0
    v_add_f32 v128, 1.0, v128
    v_rcp_f32 v128, v128
    s_lshl_b32 s100, s3, 2
    s_add_u32 s100, s100, 158208
    v_mov_b32 v129, s100
    ds_write_b32 v129, v128
    s_waitcnt lgkmcnt(0)
    s_barrier
    v_mov_b32 v128, 158208
    ds_read_b128 v[132:135], v128
    s_waitcnt lgkmcnt(0)
    v_readfirstlane_b32 s12, v132
    v_readfirstlane_b32 s13, v133
    v_readfirstlane_b32 s14, v134
    v_readfirstlane_b32 s15, v135
    ds_read_b64_tr_b16 a[80:81], v26 offset:0
    ds_read_b64_tr_b16 a[82:83], v26 offset:2048
    ds_read_b128 v[64:67], v22 offset:0
    ds_read_b64_tr_b16 a[84:85], v26 offset:4096
    ds_read_b64_tr_b16 a[86:87], v26 offset:6144
    ds_read_b128 v[68:71], v22 offset:64
    s_waitcnt lgkmcnt(0)
    v_mfma_f32_16x16x32_bf16 v[28:31], v[64:67], a[80:83], 0
    v_mfma_f32_16x16x32_bf16 v[28:31], v[68:71], a[84:87], v[28:31]
    ds_read_b64_tr_b16 a[64:65], v25 offset:0
    ds_read_b64_tr_b16 a[66:67], v25 offset:2048
    ds_read_b64_tr_b16 a[68:69], v25 offset:4096
    ds_read_b64_tr_b16 a[70:71], v25 offset:6144
    ds_read_b64_tr_b16 a[72:73], v25 offset:8192
    ds_read_b64_tr_b16 a[74:75], v25 offset:10240
    ds_read_b64_tr_b16 a[76:77], v25 offset:12288
    ds_read_b64_tr_b16 a[78:79], v25 offset:14336
    s_waitcnt vmcnt(8)
    s_mov_b32 s101, 0
L_s_chk:
    v_cmp_ne_u32 vcc, s72, v113
    s_cbranch_vccz L_s_ok
    s_add_u32 s101, s101, 1
    s_cmp_gt_u32 s101, 100000
    s_cbranch_scc1 L_s_ok
    global_load_dwordx2 v[112:113], v38, s[26:27] sc1
    s_waitcnt vmcnt(0)
    s_branch L_s_chk
L_s_ok:
    v_mov_b32_dpp v114, v112 row_shr:2 row_mask:0xf bank_mask:0xf
    v_mov_b32 v115, v114
    s_nop 1
    v_max_f32_dpp v115, v115, v115 row_ror:4 row_mask:0xf bank_mask:0xf
    s_nop 1
    v_max_f32_dpp v115, v115, v115 row_ror:8 row_mask:0xf bank_mask:0xf
    v_mov_b32 v116, v115
    s_nop 1
    v_permlane16_swap_b32 v115, v116
    v_max_f32 v115, v115, v116
    v_sub_f32 v114, v114, v115
    v_exp_f32 v114, v114
    s_nop 0
    v_mul_f32 v115, v114, v112
    s_nop 1
    v_add_f32_dpp v115, v115, v115 row_ror:4 row_mask:0xf bank_mask:0xf
    s_nop 1
    v_add_f32_dpp v115, v115, v115 row_ror:8 row_mask:0xf bank_mask:0xf
    v_mov_b32 v116, v115
    s_nop 1
    v_permlane16_swap_b32 v115, v116
    v_add_f32 v115, v115, v116
    v_rcp_f32 v115, v115
    s_lshr_b32 s100, s66, 1
    s_add_u32 s100, s100, 2
    v_mul_f32 v114, v114, v115
    s_nop 0
    v_readlane_b32 s4, v114, s100
    s_add_u32 s100, s100, 4
    v_readlane_b32 s5, v114, s100
    s_add_u32 s100, s100, 4
    v_readlane_b32 s6, v114, s100
    s_add_u32 s100, s100, 4
    v_readlane_b32 s7, v114, s100
    s_add_u32 s100, s100, 4
    v_readlane_b32 s8, v114, s100
    s_add_u32 s100, s100, 4
    v_readlane_b32 s9, v114, s100
    s_add_u32 s100, s100, 4
    v_readlane_b32 s10, v114, s100
    s_add_u32 s100, s100, 4
    v_readlane_b32 s11, v114, s100
    s_waitcnt vmcnt(0)
    v_cmp_ne_u32 vcc, s72, v97
    v_cmp_ne_u32 s[96:97], s72, v99
    s_or_b64 vcc, vcc, s[96:97]
    v_cmp_ne_u32 s[96:97], s72, v101
    s_or_b64 vcc, vcc, s[96:97]
    v_cmp_ne_u32 s[96:97], s72, v103
    s_or_b64 vcc, vcc, s[96:97]
    v_cmp_ne_u32 s[96:97], s72, v105
    s_or_b64 vcc, vcc, s[96:97]
    v_cmp_ne_u32 s[96:97], s72, v107
    s_or_b64 vcc, vcc, s[96:97]
    v_cmp_ne_u32 s[96:97], s72, v109
    s_or_b64 vcc, vcc, s[96:97]
    v_cmp_ne_u32 s[96:97], s72, v111
    s_or_b64 vcc, vcc, s[96:97]
    s_cbranch_vccz L_o_ok
    s_mov_b32 s101, 0
    global_load_dwordx2 v[96:97], v36, s[26:27] offset:-4096 sc1
    global_load_dwordx2 v[98:99], v36, s[26:27] offset:-2048 sc1
    global_load_dwordx2 v[100:101], v36, s[26:27] offset:0 sc1
    global_load_dwordx2 v[102:103], v36, s[26:27] offset:2048 sc1
    global_load_dwordx2 v[104:105], v37, s[26:27] offset:-4096 sc1
    global_load_dwordx2 v[106:107], v37, s[26:27] offset:-2048 sc1
    global_load_dwordx2 v[108:109], v37, s[26:27] offset:0 sc1
    global_load_dwordx2 v[110:111], v37, s[26:27] offset:2048 sc1
    s_sleep 7
    global_load_dwordx2 v[192:193], v36, s[26:27] offset:-4096 sc1
    global_load_dwordx2 v[194:195], v36, s[26:27] offset:-2048 sc1
    global_load_dwordx2 v[196:197], v36, s[26:27] offset:0 sc1
    global_load_dwordx2 v[198:199], v36, s[26:27] offset:2048 sc1
    global_load_dwordx2 v[200:201], v37, s[26:27] offset:-4096 sc1
    global_load_dwordx2 v[202:203], v37, s[26:27] offset:-2048 sc1
    global_load_dwordx2 v[204:205], v37, s[26:27] offset:0 sc1
    global_load_dwordx2 v[206:207], v37, s[26:27] offset:2048 sc1
L_o_loop:
    s_waitcnt vmcnt(8)
    v_cmp_ne_u32 vcc, s72, v97
    v_cmp_ne_u32 s[96:97], s72, v99
    s_or_b64 vcc, vcc, s[96:97]
    v_cmp_ne_u32 s[96:97], s72, v101
    s_or_b64 vcc, vcc, s[96:97]
    v_cmp_ne_u32 s[96:97], s72, v103
    s_or_b64 vcc, vcc, s[96:97]
    v_cmp_ne_u32 s[96:97], s72, v105
    s_or_b64 vcc, vcc, s[96:97]
    v_cmp_ne_u32 s[96:97], s72, v107
    s_or_b64 vcc, vcc, s[96:97]
    v_cmp_ne_u32 s[96:97], s72, v109
    s_or_b64 vcc, vcc, s[96:97]
    v_cmp_ne_u32 s[96:97], s72, v111
    s_or_b64 vcc, vcc, s[96:97]
    s_cbranch_vccz L_o_ok
    global_load_dwordx2 v[96:97], v36, s[26:27] offset:-4096 sc1
    global_load_dwordx2 v[98:99], v36, s[26:27] offset:-2048 sc1
    global_load_dwordx2 v[100:101], v36, s[26:27] offset:0 sc1
    global_load_dwordx2 v[102:103], v36, s[26:27] offset:2048 sc1
    global_load_dwordx2 v[104:105], v37, s[26:27] offset:-4096 sc1
    global_load_dwordx2 v[106:107], v37, s[26:27] offset:-2048 sc1
    global_load_dwordx2 v[108:109], v37, s[26:27] offset:0 sc1
    global_load_dwordx2 v[110:111], v37, s[26:27] offset:2048 sc1
    s_waitcnt vmcnt(8)
    v_cmp_ne_u32 vcc, s72, v193
    v_cmp_ne_u32 s[96:97], s72, v195
    s_or_b64 vcc, vcc, s[96:97]
    v_cmp_ne_u32 s[96:97], s72, v197
    s_or_b64 vcc, vcc, s[96:97]
    v_cmp_ne_u32 s[96:97], s72, v199
    s_or_b64 vcc, vcc, s[96:97]
    v_cmp_ne_u32 s[96:97], s72, v201
    s_or_b64 vcc, vcc, s[96:97]
    v_cmp_ne_u32 s[96:97], s72, v203
    s_or_b64 vcc, vcc, s[96:97]
    v_cmp_ne_u32 s[96:97], s72, v205
    s_or_b64 vcc, vcc, s[96:97]
    v_cmp_ne_u32 s[96:97], s72, v207
    s_or_b64 vcc, vcc, s[96:97]
    s_cbranch_vccz L_o_okB
    global_load_dwordx2 v[192:193], v36, s[26:27] offset:-4096 sc1
    global_load_dwordx2 v[194:195], v36, s[26:27] offset:-2048 sc1
    global_load_dwordx2 v[196:197], v36, s[26:27] offset:0 sc1
    global_load_dwordx2 v[198:199], v36, s[26:27] offset:2048 sc1
    global_load_dwordx2 v[200:201], v37, s[26:27] offset:-4096 sc1
    global_load_dwordx2 v[202:203], v37, s[26:27] offset:-2048 sc1
    global_load_dwordx2 v[204:205], v37, s[26:27] offset:0 sc1
    global_load_dwordx2 v[206:207], v37, s[26:27] offset:2048 sc1
    s_add_u32 s101, s101, 1
    s_cmp_gt_u32 s101, 100000
    s_cbranch_scc0 L_o_loop
L_o_okB:
    v_mov_b32 v96, v192
    v_mov_b32 v98, v194
    v_mov_b32 v100, v196
    v_mov_b32 v102, v198
    v_mov_b32 v104, v200
    v_mov_b32 v106, v202
    v_mov_b32 v108, v204
    v_mov_b32 v110, v206
L_o_ok:
    v_lshlrev_b32 v119, 16, v96
    v_and_b32 v120, 0xffff0000, v96
    v_mul_f32 v117, s4, v119
    v_mul_f32 v118, s4, v120
    v_lshlrev_b32 v119, 16, v98
    v_and_b32 v120, 0xffff0000, v98
    v_fmac_f32 v117, s5, v119
    v_fmac_f32 v118, s5, v120
    v_lshlrev_b32 v119, 16, v100
    v_and_b32 v120, 0xffff0000, v100
    v_fmac_f32 v117, s6, v119
    v_fmac_f32 v118, s6, v120
    v_lshlrev_b32 v119, 16, v102
    v_and_b32 v120, 0xffff0000, v102
    v_fmac_f32 v117, s7, v119
    v_fmac_f32 v118, s7, v120
    v_lshlrev_b32 v119, 16, v104
    v_and_b32 v120, 0xffff0000, v104
    v_fmac_f32 v117, s8, v119
    v_fmac_f32 v118, s8, v120
    v_lshlrev_b32 v119, 16, v106
    v_and_b32 v120, 0xffff0000, v106
    v_fmac_f32 v117, s9, v119
    v_fmac_f32 v118, s9, v120
    v_lshlrev_b32 v119, 16, v108
    v_and_b32 v120, 0xffff0000, v108
    v_fmac_f32 v117, s10, v119
    v_fmac_f32 v118, s10, v120
    v_lshlrev_b32 v119, 16, v110
    v_and_b32 v120, 0xffff0000, v110
    v_fmac_f32 v117, s11, v119
    v_fmac_f32 v118, s11, v120
    v_cvt_pk_bf16_f32 v117, v117, v118
    ds_write_b32 v39, v117
    s_waitcnt lgkmcnt(0)
    s_barrier
    ds_read_b128 v[144:147], v27 offset:0
    ds_read_b128 v[148:151], v27 offset:64
    ds_read_b128 v[152:155], v27 offset:128
    ds_read_b128 v[156:159], v27 offset:192
    s_waitcnt lgkmcnt(3)
    v_mfma_f32_16x16x32_bf16 v[20:23], v[144:147], a[64:67], 0
    s_waitcnt lgkmcnt(2)
    v_mfma_f32_16x16x32_bf16 v[20:23], v[148:151], a[68:71], v[20:23]
    s_waitcnt lgkmcnt(1)
    v_mfma_f32_16x16x32_bf16 v[20:23], v[152:155], a[72:75], v[20:23]
    s_waitcnt lgkmcnt(0)
    v_mfma_f32_16x16x32_bf16 v[20:23], v[156:159], a[76:79], v[20:23]
    s_nop 7
    v_sub_f32 v160, v20, v28
    v_fma_f32 v160, v160, s12, v28
    v_sub_f32 v161, v21, v29
    v_fma_f32 v161, v161, s13, v29
    v_sub_f32 v162, v22, v30
    v_fma_f32 v162, v162, s14, v30
    v_sub_f32 v163, v23, v31
    v_fma_f32 v163, v163, s15, v31
    s_mov_b32 exec_lo, 0xffff0000
    s_mov_b32 exec_hi, 0
    v_mov_b32 v160, v161
    s_mov_b32 exec_lo, 0
    s_mov_b32 exec_hi, 0xffff
    v_mov_b32 v160, v162
    s_mov_b32 exec_lo, 0
    s_mov_b32 exec_hi, 0xffff0000
    v_mov_b32 v160, v163
    s_mov_b64 exec, -1
    v_mov_b32 v46, v160
    global_store_dwordx2 v40, v[46:47], s[26:27] sc1
    s_sub_u32 s100, 7, s66
    s_cmp_eq_u32 s65, s100
    s_cbranch_scc0 L_fin
    global_load_dwordx2 v[208:209], v41, s[26:27] offset:-4096 sc1
    global_load_dwordx2 v[210:211], v41, s[26:27] offset:-2048 sc1
    global_load_dwordx2 v[212:213], v41, s[26:27] offset:0 sc1
    global_load_dwordx2 v[214:215], v41, s[26:27] offset:2048 sc1
    global_load_dwordx2 v[216:217], v42, s[26:27] offset:-4096 sc1
    global_load_dwordx2 v[218:219], v42, s[26:27] offset:-2048 sc1
    global_load_dwordx2 v[220:221], v42, s[26:27] offset:0 sc1
    global_load_dwordx2 v[222:223], v42, s[26:27] offset:2048 sc1
    s_waitcnt vmcnt(0)
    v_cmp_ne_u32 vcc, s72, v209
    v_cmp_ne_u32 s[96:97], s72, v211
    s_or_b64 vcc, vcc, s[96:97]
    v_cmp_ne_u32 s[96:97], s72, v213
    s_or_b64 vcc, vcc, s[96:97]
    v_cmp_ne_u32 s[96:97], s72, v215
    s_or_b64 vcc, vcc, s[96:97]
    v_cmp_ne_u32 s[96:97], s72, v217
    s_or_b64 vcc, vcc, s[96:97]
    v_cmp_ne_u32 s[96:97], s72, v219
    s_or_b64 vcc, vcc, s[96:97]
    v_cmp_ne_u32 s[96:97], s72, v221
    s_or_b64 vcc, vcc, s[96:97]
    v_cmp_ne_u32 s[96:97], s72, v223
    s_or_b64 vcc, vcc, s[96:97]
    s_cbranch_vccz L_y_ok
    s_mov_b32 s101, 0
    global_load_dwordx2 v[208:209], v41, s[26:27] offset:-4096 sc1
    global_load_dwordx2 v[210:211], v41, s[26:27] offset:-2048 sc1
    global_load_dwordx2 v[212:213], v41, s[26:27] offset:0 sc1
    global_load_dwordx2 v[214:215], v41, s[26:27] offset:2048 sc1
    global_load_dwordx2 v[216:217], v42, s[26:27] offset:-4096 sc1
    global_load_dwordx2 v[218:219], v42, s[26:27] offset:-2048 sc1
    global_load_dwordx2 v[220:221], v42, s[26:27] offset:0 sc1
    global_load_dwordx2 v[222:223], v42, s[26:27] offset:2048 sc1
    s_sleep 7
    global_load_dwordx2 v[224:225], v41, s[26:27] offset:-4096 sc1
    global_load_dwordx2 v[226:227], v41, s[26:27] offset:-2048 sc1
    global_load_dwordx2 v[228:229], v41, s[26:27] offset:0 sc1
    global_load_dwordx2 v[230:231], v41, s[26:27] offset:2048 sc1
    global_load_dwordx2 v[232:233], v42, s[26:27] offset:-4096 sc1
    global_load_dwordx2 v[234:235], v42, s[26:27] offset:-2048 sc1
    global_load_dwordx2 v[236:237], v42, s[26:27] offset:0 sc1
    global_load_dwordx2 v[238:239], v42, s[26:27] offset:2048 sc1
L_y_loop:
    s_waitcnt vmcnt(8)
    v_cmp_ne_u32 vcc, s72, v209
    v_cmp_ne_u32 s[96:97], s72, v211
    s_or_b64 vcc, vcc, s[96:97]
    v_cmp_ne_u32 s[96:97], s72, v213
    s_or_b64 vcc, vcc, s[96:97]
    v_cmp_ne_u32 s[96:97], s72, v215
    s_or_b64 vcc, vcc, s[96:97]
    v_cmp_ne_u32 s[96:97], s72, v217
    s_or_b64 vcc, vcc, s[96:97]
    v_cmp_ne_u32 s[96:97], s72, v219
    s_or_b64 vcc, vcc, s[96:97]
    v_cmp_ne_u32 s[96:97], s72, v221
    s_or_b64 vcc, vcc, s[96:97]
    v_cmp_ne_u32 s[96:97], s72, v223
    s_or_b64 vcc, vcc, s[96:97]
    s_cbranch_vccz L_y_ok
    global_load_dwordx2 v[208:209], v41, s[26:27] offset:-4096 sc1
    global_load_dwordx2 v[210:211], v41, s[26:27] offset:-2048 sc1
    global_load_dwordx2 v[212:213], v41, s[26:27] offset:0 sc1
    global_load_dwordx2 v[214:215], v41, s[26:27] offset:2048 sc1
    global_load_dwordx2 v[216:217], v42, s[26:27] offset:-4096 sc1
    global_load_dwordx2 v[218:219], v42, s[26:27] offset:-2048 sc1
    global_load_dwordx2 v[220:221], v42, s[26:27] offset:0 sc1
    global_load_dwordx2 v[222:223], v42, s[26:27] offset:2048 sc1
    s_waitcnt vmcnt(8)
    v_cmp_ne_u32 vcc, s72, v225
    v_cmp_ne_u32 s[96:97], s72, v227
    s_or_b64 vcc, vcc, s[96:97]
    v_cmp_ne_u32 s[96:97], s72, v229
    s_or_b64 vcc, vcc, s[96:97]
    v_cmp_ne_u32 s[96:97], s72, v231
    s_or_b64 vcc, vcc, s[96:97]
    v_cmp_ne_u32 s[96:97], s72, v233
    s_or_b64 vcc, vcc, s[96:97]
    v_cmp_ne_u32 s[96:97], s72, v235
    s_or_b64 vcc, vcc, s[96:97]
    v_cmp_ne_u32 s[96:97], s72, v237
    s_or_b64 vcc, vcc, s[96:97]
    v_cmp_ne_u32 s[96:97], s72, v239
    s_or_b64 vcc, vcc, s[96:97]
    s_cbranch_vccz L_y_okB
    global_load_dwordx2 v[224:225], v41, s[26:27] offset:-4096 sc1
    global_load_dwordx2 v[226:227], v41, s[26:27] offset:-2048 sc1
    global_load_dwordx2 v[228:229], v41, s[26:27] offset:0 sc1
    global_load_dwordx2 v[230:231], v41, s[26:27] offset:2048 sc1
    global_load_dwordx2 v[232:233], v42, s[26:27] offset:-4096 sc1
    global_load_dwordx2 v[234:235], v42, s[26:27] offset:-2048 sc1
    global_load_dwordx2 v[236:237], v42, s[26:27] offset:0 sc1
    global_load_dwordx2 v[238:239], v42, s[26:27] offset:2048 sc1
    s_add_u32 s101, s101, 1
    s_cmp_gt_u32 s101, 100000
    s_cbranch_scc0 L_y_loop
L_y_okB:
    v_mov_b32 v208, v224
    v_mov_b32 v210, v226
    v_mov_b32 v212, v228
    v_mov_b32 v214, v230
    v_mov_b32 v216, v232
    v_mov_b32 v218, v234
    v_mov_b32 v220, v236
    v_mov_b32 v222, v238
L_y_ok:
    v_add_f32 v64, v208, v210
    v_add_f32 v65, v212, v214
    v_add_f32 v66, v216, v218
    v_add_f32 v67, v220, v222
    v_add_f32 v64, v64, v65
    v_add_f32 v66, v66, v67
    v_add_f32 v64, v64, v66
    v_mov_b32 v65, v64
    s_nop 1
    v_permlane16_swap_b32 v64, v65
    v_add_f32 v64, v64, v65
    v_mov_b32 v65, v64
    s_nop 1
    v_permlane32_swap_b32 v64, v65
    v_add_f32 v64, v64, v65
    v_cvt_pk_bf16_f32 v64, v64, v64
    s_mov_b64 exec, 0xffff
    buffer_store_short v64, v43, s[56:59], s52 offen
    s_cmp_eq_u32 s2, 15
    s_cbranch_scc0 L_fin
    s_cmp_eq_u32 s3, 0
    s_cbranch_scc0 L_fin
    v_mov_b32 v66, s72
    v_mov_b32 v67, 1015808
    s_mov_b64 exec, 1
    global_store_dword v67, v66, s[26:27] sc1
L_fin:
L_end:
    s_endpgm
L_code_end:
.section .rodata,"a"
.p2align 6
.amdhsa_kernel gated_mix__gqa_block_cached__dense_activation_relu__decode_kernel
  .amdhsa_next_free_vgpr 512
  .amdhsa_next_free_sgpr 102
  .amdhsa_accum_offset 256
  .amdhsa_group_segment_fixed_size 0
  .amdhsa_kernarg_size 96
  .amdhsa_user_sgpr_count 2
  .amdhsa_user_sgpr_kernarg_segment_ptr 1
  .amdhsa_system_sgpr_workgroup_id_x 1
.end_amdhsa_kernel
```
